```python
import torch

def _softmax(x, axis=-1):
    return torch.softmax(x, dim=axis)
def _gelu(x):
    return torch.nn.functional.gelu(x, approximate="tanh")
def _silu(x):
    return torch.nn.functional.silu(x)
def _sigmoid(x):
    return torch.sigmoid(x)
def _layernorm(x, axis=-1, eps=1e-5):
    m = x.mean(dim=axis, keepdim=True)
    v = x.var(dim=axis, keepdim=True, unbiased=False)
    return (x - m) / torch.sqrt(v + eps)
def _scatter_add(tgt, idx, src, axis=0):
    return tgt.clone().index_add_(axis, idx, src)
def _segment_sum(src, seg, n):
    out = torch.zeros((n,) + src.shape[1:], dtype=src.dtype)
    return out.index_add_(0, seg, src)
def _pad(x, pw):
    flat = tuple(v for pair in reversed(pw) for v in pair)
    return torch.nn.functional.pad(x, flat)

kernel_name = 'concat_heads__mha_block__linear_attn_block__prompt'

def setup_inputs():

    _w = (lambda a: (lambda t: t.to(torch.bfloat16) if t.is_floating_point() else t)(torch.as_tensor(a)))
    def _A_setup():
        B, S, D, H = 1, 2048, 640, 32
        return {
            "x": _w((lambda *s: torch.randn(*s, dtype=torch.bfloat16) * 0.2)(B, S, D)),
            "wqkv": _w((lambda *s: torch.randn(*s, dtype=torch.bfloat16) * 0.2)(D, 3 * D)),
            "wo": _w((lambda *s: torch.randn(*s, dtype=torch.bfloat16) * 0.05)(D, D)),
        }
    _A_in = _A_setup()

    def _B_setup():
        B, S, D = 1, 2048, 640
        return {
            "x": _w((lambda *s: torch.randn(*s, dtype=torch.bfloat16) * 0.05)(B, S, D)),
            "wqkv": _w((lambda *s: torch.randn(*s, dtype=torch.bfloat16) * 1.6)(D, 3 * D)),
            "wo": _w((lambda *s: torch.randn(*s, dtype=torch.bfloat16) * 0.05)(D, D)),
        }
    _B_in = _B_setup()

    return {
        "A_x": _A_in["x"],
        "A_wqkv": _A_in["wqkv"],
        "A_wo": _A_in["wo"],
        "B_x": _B_in["x"],
        "B_wqkv": _B_in["wqkv"],
        "B_wo": _B_in["wo"],
    }

def reference(A_x, A_wqkv, A_wo, B_x, B_wqkv, B_wo):
    def _A_ref(x, wqkv, wo):
        B, S, D = x.shape
        H = 32
        Dh = D // H
        qkv = (lambda x, *d: x.permute(*d))((x @ wqkv).reshape(B, S, 3, H, Dh), 2, 0, 3, 1, 4)
        q, k, v = qkv[0], qkv[1], qkv[2]
        scores = torch.einsum("bhqd,bhkd->bhqk", q, k) * (Dh ** -0.5)
        p = _softmax(scores, axis=-1)
        o = torch.einsum("bhqk,bhkd->bhqd", p, v)
        return (lambda x, *d: x.permute(*d))(o, 0, 2, 1, 3).reshape(B, S, D) @ wo

    def _B_ref(x, wqkv, wo):
        B, S, D = x.shape
        H = 32; Dh = D // H
        qkv = (lambda x, *d: x.permute(*d))((x @ wqkv).reshape(B, S, 3, H, Dh), 2, 0, 3, 1, 4)
        q, k, v = qkv[0], qkv[1], qkv[2]
        phi = lambda t: torch.where(t > 0, t + 1, torch.exp(t)) + 1e-6
        pq, pk = phi(q), phi(k)
        kv = torch.einsum("bhsd,bhse->bhde", pk, v)
        z = torch.einsum("bhsd->bhd", pk)
        num = torch.einsum("bhqd,bhde->bhqe", pq, kv)
        den = torch.einsum("bhqd,bhd->bhq", pq, z)[..., None] + 1e-6
        o = num / den
        return (lambda x, *d: x.permute(*d))(o, 0, 2, 1, 3).reshape(B, S, D) @ wo

    a = _A_ref(A_x, A_wqkv, A_wo)
    b = _B_ref(B_x, B_wqkv, B_wo)
    return torch.concatenate([a, b], axis=-1)
```

```asm
; @launch grid=(256,1,1) block=(512,1,1) lds=163840
.amdgcn_target "amdgcn-amd-amdhsa--gfx950"
.text
.globl concat_heads__mha_block__linear_attn_block__prompt_kernel
.p2align 8
.type concat_heads__mha_block__linear_attn_block__prompt_kernel,@function
concat_heads__mha_block__linear_attn_block__prompt_kernel:
  s_cmp_ge_u32 s2, 256
  s_cbranch_scc1 f_end
  s_load_dwordx4 s[36:39], s[0:1], 0
  s_load_dwordx2 s[40:41], s[0:1], 16
  s_load_dwordx4 s[32:35], s[0:1], 24
  s_load_dwordx2 s[42:43], s[0:1], 40
  s_load_dwordx4 s[44:47], s[0:1], 48
  s_load_dwordx2 s[12:13], s[0:1], 64
  v_and_b32 v1, 63, v0
  v_lshrrev_b32 v8, 6, v0
  s_and_b32 s3, s2, 7
  v_readfirstlane_b32 s16, v8
  s_lshr_b32 s48, s2, 3
  s_lshr_b32 s98, s3, 2
  s_and_b32 s17, s3, 1
  s_lshl_b32 s17, s17, 3
  s_and_b32 s49, s48, 7
  s_add_u32 s17, s17, s49
  s_bfe_u32 s18, s3, 0x10001
  s_lshl_b32 s18, s18, 2
  s_lshr_b32 s50, s48, 3
  s_add_u32 s18, s18, s50
  s_mul_i32 s50, s50, 3
  s_add_u32 s49, s49, s50
  s_sub_u32 s50, s49, 10
  s_cmp_ge_u32 s49, 10
  s_cselect_b32 s49, s50, s49
  s_and_b32 s57, s16, 3
  s_cmp_lt_u32 s16, 4
  s_cbranch_scc1 f_comp
  s_lshl_b32 s50, s17, 7
  s_lshl_b32 s51, s57, 5
  s_add_u32 s50, s50, s51
  v_lshrrev_b32 v10, 3, v1
  v_add_u32 v10, s50, v10
  v_mul_u32_u24 v10, 1280, v10
  v_bfe_u32 v11, v1, 4, 1
  v_and_b32 v12, 7, v1
  v_xor_b32 v11, v11, v12
  v_xor_b32 v12, 0, v11
  v_lshl_add_u32 v58, v12, 4, v10
  v_xor_b32 v12, 2, v11
  v_lshl_add_u32 v59, v12, 4, v10
  v_add_u32 v59, 9216, v59
  v_xor_b32 v12, 4, v11
  v_lshl_add_u32 v60, v12, 4, v10
  v_add_u32 v60, 18432, v60
  v_xor_b32 v12, 6, v11
  v_lshl_add_u32 v61, v12, 4, v10
  v_add_u32 v61, 27648, v61
  s_mul_i32 s50, s49, 245760
  s_lshl_b32 s51, s49, 7
  s_lshl_b32 s53, s57, 13
  s_lshl_b32 s56, s57, 12
  s_add_u32 s56, s56, 32768
  s_mov_b32 m0, s56
  s_waitcnt lgkmcnt(0)
  s_cmp_eq_u32 s98, 0
  s_cselect_b32 s4, s36, s32
  s_cselect_b32 s5, s37, s33
  s_mov_b32 s6, 2621440
  s_mov_b32 s7, 0x20000
  s_cselect_b32 s8, s38, s34
  s_cselect_b32 s9, s39, s35
  s_mov_b32 s10, 2457600
  s_mov_b32 s11, 0x20000
  buffer_load_dwordx4 v58, s[4:7], s51 offen offset:0 lds
  buffer_load_dwordx4 v59, s[4:7], s51 offen offset:1024 lds
  buffer_load_dwordx4 v60, s[4:7], s51 offen offset:2048 lds
  buffer_load_dwordx4 v61, s[4:7], s51 offen offset:3072 lds
  s_lshl_b32 s54, s57, 9
  s_mul_i32 s55, s18, 160
  s_mov_b32 s52, 0x8889
  s_mov_b32 s58, 0x199a
  s_mov_b32 m0, s53
  v_add_u32 v10, s54, v1
  v_mul_u32_u24 v11, s52, v10
  v_lshrrev_b32 v11, 20, v11
  v_mul_u32_u24 v15, 30, v11
  v_sub_u32 v12, v10, v15
  v_mul_u32_u24 v13, s58, v12
  v_lshrrev_b32 v13, 16, v13
  v_mul_u32_u24 v13, 1120, v13
  v_and_b32 v14, 35, v11
  v_bfe_u32 v15, v11, 2, 2
  v_lshl_add_u32 v14, v15, 3, v14
  v_bfe_u32 v15, v11, 4, 1
  v_lshl_add_u32 v14, v15, 2, v14
  v_mul_u32_u24 v14, 3840, v14
  v_lshl_add_u32 v14, v12, 4, v14
  v_add3_u32 v50, v14, v13, s55
  buffer_load_dwordx4 v50, s[8:11], s50 offen offset:0 lds
  v_add_u32 v10, s54, v1
  v_add_u32 v10, 64, v10
  v_mul_u32_u24 v11, s52, v10
  v_lshrrev_b32 v11, 20, v11
  v_mul_u32_u24 v15, 30, v11
  v_sub_u32 v12, v10, v15
  v_mul_u32_u24 v13, s58, v12
  v_lshrrev_b32 v13, 16, v13
  v_mul_u32_u24 v13, 1120, v13
  v_and_b32 v14, 35, v11
  v_bfe_u32 v15, v11, 2, 2
  v_lshl_add_u32 v14, v15, 3, v14
  v_bfe_u32 v15, v11, 4, 1
  v_lshl_add_u32 v14, v15, 2, v14
  v_mul_u32_u24 v14, 3840, v14
  v_lshl_add_u32 v14, v12, 4, v14
  v_add3_u32 v51, v14, v13, s55
  v_subrev_u32 v51, 1024, v51
  buffer_load_dwordx4 v51, s[8:11], s50 offen offset:1024 lds
  v_add_u32 v10, s54, v1
  v_add_u32 v10, 128, v10
  v_mul_u32_u24 v11, s52, v10
  v_lshrrev_b32 v11, 20, v11
  v_mul_u32_u24 v15, 30, v11
  v_sub_u32 v12, v10, v15
  v_mul_u32_u24 v13, s58, v12
  v_lshrrev_b32 v13, 16, v13
  v_mul_u32_u24 v13, 1120, v13
  v_and_b32 v14, 35, v11
  v_bfe_u32 v15, v11, 2, 2
  v_lshl_add_u32 v14, v15, 3, v14
  v_bfe_u32 v15, v11, 4, 1
  v_lshl_add_u32 v14, v15, 2, v14
  v_mul_u32_u24 v14, 3840, v14
  v_lshl_add_u32 v14, v12, 4, v14
  v_add3_u32 v52, v14, v13, s55
  v_subrev_u32 v52, 2048, v52
  buffer_load_dwordx4 v52, s[8:11], s50 offen offset:2048 lds
  v_add_u32 v10, s54, v1
  v_add_u32 v10, 192, v10
  v_mul_u32_u24 v11, s52, v10
  v_lshrrev_b32 v11, 20, v11
  v_mul_u32_u24 v15, 30, v11
  v_sub_u32 v12, v10, v15
  v_mul_u32_u24 v13, s58, v12
  v_lshrrev_b32 v13, 16, v13
  v_mul_u32_u24 v13, 1120, v13
  v_and_b32 v14, 35, v11
  v_bfe_u32 v15, v11, 2, 2
  v_lshl_add_u32 v14, v15, 3, v14
  v_bfe_u32 v15, v11, 4, 1
  v_lshl_add_u32 v14, v15, 2, v14
  v_mul_u32_u24 v14, 3840, v14
  v_lshl_add_u32 v14, v12, 4, v14
  v_add3_u32 v53, v14, v13, s55
  v_subrev_u32 v53, 3072, v53
  buffer_load_dwordx4 v53, s[8:11], s50 offen offset:3072 lds
  v_add_u32 v10, s54, v1
  v_add_u32 v10, 256, v10
  v_mul_u32_u24 v11, s52, v10
  v_lshrrev_b32 v11, 20, v11
  v_mul_u32_u24 v15, 30, v11
  v_sub_u32 v12, v10, v15
  v_mul_u32_u24 v13, s58, v12
  v_lshrrev_b32 v13, 16, v13
  v_mul_u32_u24 v13, 1120, v13
  v_and_b32 v14, 35, v11
  v_bfe_u32 v15, v11, 2, 2
  v_lshl_add_u32 v14, v15, 3, v14
  v_bfe_u32 v15, v11, 4, 1
  v_lshl_add_u32 v14, v15, 2, v14
  v_mul_u32_u24 v14, 3840, v14
  v_lshl_add_u32 v14, v12, 4, v14
  v_add3_u32 v54, v14, v13, s55
  s_add_u32 m0, m0, 4096
  s_nop 0
  buffer_load_dwordx4 v54, s[8:11], s50 offen offset:0 lds
  v_add_u32 v10, s54, v1
  v_add_u32 v10, 320, v10
  v_mul_u32_u24 v11, s52, v10
  v_lshrrev_b32 v11, 20, v11
  v_mul_u32_u24 v15, 30, v11
  v_sub_u32 v12, v10, v15
  v_mul_u32_u24 v13, s58, v12
  v_lshrrev_b32 v13, 16, v13
  v_mul_u32_u24 v13, 1120, v13
  v_and_b32 v14, 35, v11
  v_bfe_u32 v15, v11, 2, 2
  v_lshl_add_u32 v14, v15, 3, v14
  v_bfe_u32 v15, v11, 4, 1
  v_lshl_add_u32 v14, v15, 2, v14
  v_mul_u32_u24 v14, 3840, v14
  v_lshl_add_u32 v14, v12, 4, v14
  v_add3_u32 v55, v14, v13, s55
  v_subrev_u32 v55, 1024, v55
  buffer_load_dwordx4 v55, s[8:11], s50 offen offset:1024 lds
  v_add_u32 v10, s54, v1
  v_add_u32 v10, 384, v10
  v_mul_u32_u24 v11, s52, v10
  v_lshrrev_b32 v11, 20, v11
  v_mul_u32_u24 v15, 30, v11
  v_sub_u32 v12, v10, v15
  v_mul_u32_u24 v13, s58, v12
  v_lshrrev_b32 v13, 16, v13
  v_mul_u32_u24 v13, 1120, v13
  v_and_b32 v14, 35, v11
  v_bfe_u32 v15, v11, 2, 2
  v_lshl_add_u32 v14, v15, 3, v14
  v_bfe_u32 v15, v11, 4, 1
  v_lshl_add_u32 v14, v15, 2, v14
  v_mul_u32_u24 v14, 3840, v14
  v_lshl_add_u32 v14, v12, 4, v14
  v_add3_u32 v56, v14, v13, s55
  v_subrev_u32 v56, 2048, v56
  v_cmp_gt_u32 vcc, 1920, v10
  v_mov_b32 v15, 2130706432
  s_nop 0
  v_cndmask_b32 v56, v15, v56, vcc
  buffer_load_dwordx4 v56, s[8:11], s50 offen offset:2048 lds
  v_add_u32 v10, s54, v1
  v_add_u32 v10, 448, v10
  v_mul_u32_u24 v11, s52, v10
  v_lshrrev_b32 v11, 20, v11
  v_mul_u32_u24 v15, 30, v11
  v_sub_u32 v12, v10, v15
  v_mul_u32_u24 v13, s58, v12
  v_lshrrev_b32 v13, 16, v13
  v_mul_u32_u24 v13, 1120, v13
  v_and_b32 v14, 35, v11
  v_bfe_u32 v15, v11, 2, 2
  v_lshl_add_u32 v14, v15, 3, v14
  v_bfe_u32 v15, v11, 4, 1
  v_lshl_add_u32 v14, v15, 2, v14
  v_mul_u32_u24 v14, 3840, v14
  v_lshl_add_u32 v14, v12, 4, v14
  v_add3_u32 v57, v14, v13, s55
  v_subrev_u32 v57, 3072, v57
  v_cmp_gt_u32 vcc, 1920, v10
  v_mov_b32 v15, 2130706432
  s_nop 0
  v_cndmask_b32 v57, v15, v57, vcc
  buffer_load_dwordx4 v57, s[8:11], s50 offen offset:3072 lds
  v_and_b32 v246, 3, v1
  v_lshlrev_b32 v246, 2, v246
  v_add_u32 v246, 162368, v246
  s_lshl_b32 s3, s57, 2
  s_add_u32 s3, s3, 162368
  v_mov_b32 v247, s3
  v_mov_b32 v49, 163776
  s_cmp_eq_u32 s98, 0
  s_cselect_b32 s20, s40, s42
  s_cselect_b32 s21, s41, s43
  s_mov_b32 s22, 819200
  s_mov_b32 s23, 0x20000
  s_mov_b32 s14, 20971520
  s_mov_b32 s15, 0x20000
  s_mov_b32 s24, s44
  s_mov_b32 s25, s45
  s_mov_b32 s26, 5242880
  s_mov_b32 s27, 0x20000
  s_mov_b32 s28, s46
  s_mov_b32 s29, s47
  s_mov_b32 s30, 256
  s_mov_b32 s31, 0x20000
  s_mov_b32 s52, 0
  s_mov_b32 s54, 1
  s_barrier
f_ll:
  s_add_u32 s49, s49, 1
  s_add_u32 s50, s50, 245760
  s_add_u32 s51, s51, 128
  s_cmp_eq_u32 s49, 10
  s_cselect_b32 s49, 0, s49
  s_cselect_b32 s50, 0, s50
  s_cselect_b32 s51, 0, s51
  s_add_u32 s52, s52, 49152
  s_cmp_eq_u32 s52, 147456
  s_cselect_b32 s52, 0, s52
  s_sub_u32 s55, s54, 2
  s_cmp_lt_u32 s54, 3
  s_cbranch_scc1 f_ll0
  s_mov_b32 s64, 0x100000
  s_branch f_lsy
f_ls:
  s_sleep 1
f_lsy:
  ds_read_b32 v248, v246 offset:16
  s_sub_u32 s64, s64, 1
  s_waitcnt lgkmcnt(0)
  v_cmp_gt_u32 vcc, s55, v248
  s_cmp_eq_u32 s64, 0
  s_cbranch_scc1 f_lsx
  s_cbranch_vccnz f_ls
f_lsx:
f_ll0:
  s_add_u32 m0, s52, s56
  v_mov_b32 v249, s54
  buffer_load_dwordx4 v58, s[4:7], s51 offen offset:0 lds
  buffer_load_dwordx4 v59, s[4:7], s51 offen offset:1024 lds
  buffer_load_dwordx4 v60, s[4:7], s51 offen offset:2048 lds
  buffer_load_dwordx4 v61, s[4:7], s51 offen offset:3072 lds
  s_add_u32 m0, s52, s53
  s_nop 0
  buffer_load_dwordx4 v50, s[8:11], s50 offen offset:0 lds
  buffer_load_dwordx4 v51, s[8:11], s50 offen offset:1024 lds
  buffer_load_dwordx4 v52, s[8:11], s50 offen offset:2048 lds
  buffer_load_dwordx4 v53, s[8:11], s50 offen offset:3072 lds
  s_waitcnt vmcnt(8)
  ds_write_b32 v247, v249
  s_add_u32 m0, m0, 4096
  s_nop 0
  buffer_load_dwordx4 v54, s[8:11], s50 offen offset:0 lds
  buffer_load_dwordx4 v55, s[8:11], s50 offen offset:1024 lds
  buffer_load_dwordx4 v56, s[8:11], s50 offen offset:2048 lds
  buffer_load_dwordx4 v57, s[8:11], s50 offen offset:3072 lds
  s_cmp_lg_u32 s54, 6
  s_cbranch_scc1 f_ln
  v_mov_b32 v9, 0
  buffer_load_dword v20, v9, s[28:31], 0 offen sc1
f_ln:
  s_add_u32 s54, s54, 1
  s_cmp_lt_u32 s54, 10
  s_cbranch_scc1 f_ll
  v_readfirstlane_b32 s19, v20
  s_nop 3
  s_cmp_lg_u32 s19, 0
  s_cbranch_scc1 fl_np2
  v_mov_b32 v9, 0
  s_mov_b32 s64, 0x20000
fl_np:
  buffer_load_dword v20, v9, s[28:31], 0 offen sc1
  s_waitcnt vmcnt(0)
  v_readfirstlane_b32 s19, v20
  s_sub_u32 s64, s64, 1
  s_cmp_eq_u32 s64, 0
  s_cbranch_scc1 fl_np2
  s_nop 0
  s_cmp_eq_u32 s19, 0
  s_cbranch_scc1 fl_np
fl_np2:
  ds_write_b32 v49, v20 offset:36
  v_lshlrev_b32 v2, 4, v1
  v_and_b32 v8, 31, v1
  v_lshrrev_b32 v9, 5, v1
  v_mul_u32_u24 v4, 336, v9
  v_lshl_add_u32 v4, v8, 4, v4
  v_mov_b32 v10, 2130706432
  v_cmp_gt_u32 vcc, 21, v8
  s_nop 1
  v_cndmask_b32 v4, v10, v4, vcc
  v_lshlrev_b32 v3, 3, v8
  v_mov_b32 v10, 576
  v_cmp_gt_u32 vcc, 32, v1
  s_nop 1
  v_cndmask_b32 v3, v10, v3, vcc
  v_mov_b32 v5, 0xdddddddd
  s_lshr_b32 s58, s16, 2
  s_lshl_b32 s59, s18, 1
  s_add_u32 s59, s59, s98
  s_lshl_b32 s59, s59, 1
  s_add_u32 s59, s59, s58
  s_lshl_b32 s3, s17, 2
  s_add_u32 s3, s3, s57
  s_mov_b32 s55, s3
  s_mul_i32 s3, s3, 40960
  v_lshrrev_b32 v10, 4, v8
  v_mul_u32_u24 v10, 20480, v10
  v_add_u32 v10, s3, v10
  v_and_b32 v11, 15, v8
  v_lshl_add_u32 v6, v11, 4, v10
  v_lshl_add_u32 v6, v9, 8, v6
  s_lshr_b32 s3, s59, 1
  s_lshl_b32 s3, s3, 9
  s_lshl_b32 s62, s58, 13
  s_add_u32 s3, s3, s62
  v_add_u32 v6, s3, v6
  v_lshl_add_u32 v10, v11, 3, v10
  s_lshr_b32 s3, s59, 1
  s_lshl_b32 s3, s3, 7
  s_lshl_b32 s62, s58, 11
  s_add_u32 s3, s3, s62
  s_add_u32 s3, s3, 16384
  v_add_u32 v10, s3, v10
  v_mov_b32 v11, 2130706432
  v_cndmask_b32 v7, v11, v10, vcc
  s_mul_i32 s63, s59, 172032
  s_mov_b32 s60, 1069066811
  s_mov_b32 s61, s60
  s_mov_b32 s96, 897988541
  s_mov_b32 s97, s96
  s_mov_b32 s62, 0x07060302
  v_mov_b32 v249, 99
  s_waitcnt vmcnt(0)
  ds_write_b32 v247, v249
  s_mul_i32 s3, s18, 160
  s_mov_b32 s52, 0x199a
  s_lshl_b32 s3, s18, 8
  s_add_u32 s3, s3, s55
  s_mul_i32 s40, s3, 2688
  s_mul_i32 s41, s3, 1408
  s_mul_i32 s42, s98, 2703360
  s_add_u32 s41, s41, s42
  s_add_u32 s41, s41, 5816320
  s_lshl_b32 s48, s3, 2
  s_add_u32 s48, s48, 12451840
  s_mov_b32 s42, 820
  s_mov_b32 s43, 745
  s_mov_b32 s44, 170624
  s_mov_b32 s45, 88704
  s_mov_b32 s46, 170752
  s_add_u32 s47, s40, 1280
  v_mov_b32 v13, 2130706432
  v_add_u32 v10, 0, v1
  v_mul_u32_u24 v11, s43, v10
  v_lshrrev_b32 v11, 16, v11
  v_mul_lo_u32 v12, s44, v11
  v_lshl_add_u32 v12, v10, 4, v12
  v_add_u32 v72, s47, v12
  v_mul_lo_u32 v12, s45, v11
  v_lshl_add_u32 v12, v10, 4, v12
  v_add_u32 v83, s41, v12
  v_mul_u32_u24 v11, s42, v10
  v_lshrrev_b32 v11, 16, v11
  v_mul_lo_u32 v12, s46, v11
  v_lshl_add_u32 v12, v10, 4, v12
  v_add_u32 v78, s40, v12
  v_add_u32 v10, 64, v1
  v_mul_u32_u24 v11, s43, v10
  v_lshrrev_b32 v11, 16, v11
  v_mul_lo_u32 v12, s44, v11
  v_lshl_add_u32 v12, v10, 4, v12
  v_add_u32 v73, s47, v12
  v_mul_lo_u32 v12, s45, v11
  v_lshl_add_u32 v12, v10, 4, v12
  v_add_u32 v84, s41, v12
  v_mul_u32_u24 v11, s42, v10
  v_lshrrev_b32 v11, 16, v11
  v_mul_lo_u32 v12, s46, v11
  v_lshl_add_u32 v12, v10, 4, v12
  v_add_u32 v79, s40, v12
  v_add_u32 v10, 128, v1
  v_mul_u32_u24 v11, s43, v10
  v_lshrrev_b32 v11, 16, v11
  v_mul_lo_u32 v12, s44, v11
  v_lshl_add_u32 v12, v10, 4, v12
  v_add_u32 v74, s47, v12
  v_mul_lo_u32 v12, s45, v11
  v_lshl_add_u32 v12, v10, 4, v12
  v_add_u32 v85, s41, v12
  v_mul_u32_u24 v11, s42, v10
  v_lshrrev_b32 v11, 16, v11
  v_mul_lo_u32 v12, s46, v11
  v_lshl_add_u32 v12, v10, 4, v12
  v_add_u32 v80, s40, v12
  v_add_u32 v10, 192, v1
  v_mul_u32_u24 v11, s43, v10
  v_lshrrev_b32 v11, 16, v11
  v_mul_lo_u32 v12, s44, v11
  v_lshl_add_u32 v12, v10, 4, v12
  v_add_u32 v75, s47, v12
  v_mul_lo_u32 v12, s45, v11
  v_lshl_add_u32 v12, v10, 4, v12
  v_add_u32 v86, s41, v12
  v_mul_u32_u24 v11, s42, v10
  v_lshrrev_b32 v11, 16, v11
  v_mul_lo_u32 v12, s46, v11
  v_lshl_add_u32 v12, v10, 4, v12
  v_add_u32 v81, s40, v12
  v_add_u32 v10, 256, v1
  v_mul_u32_u24 v11, s43, v10
  v_lshrrev_b32 v11, 16, v11
  v_mul_lo_u32 v12, s44, v11
  v_lshl_add_u32 v12, v10, 4, v12
  v_add_u32 v76, s47, v12
  v_mul_lo_u32 v12, s45, v11
  v_lshl_add_u32 v12, v10, 4, v12
  v_add_u32 v87, s41, v12
  v_mul_u32_u24 v11, s42, v10
  v_lshrrev_b32 v11, 16, v11
  v_mul_lo_u32 v12, s46, v11
  v_lshl_add_u32 v12, v10, 4, v12
  v_add_u32 v82, s40, v12
  v_add_u32 v10, 320, v1
  v_mul_u32_u24 v11, s43, v10
  v_lshrrev_b32 v11, 16, v11
  v_mul_lo_u32 v12, s44, v11
  v_lshl_add_u32 v12, v10, 4, v12
  v_add_u32 v77, s47, v12
  v_mul_lo_u32 v12, s45, v11
  v_lshl_add_u32 v12, v10, 4, v12
  v_add_u32 v88, s41, v12
  v_cmp_gt_u32 vcc, 32, v1
  s_nop 1
  v_cndmask_b32 v77, v13, v77, vcc
  v_cndmask_b32 v88, v13, v88, vcc
  s_cmp_eq_u32 s98, 0
  s_cselect_b32 s3, 48, 64
  v_cmp_gt_u32 vcc, s3, v1
  s_nop 1
  v_cndmask_b32 v85, v13, v85, vcc
  v_cmp_gt_u32 vcc, 4, v1
  v_lshlrev_b32 v10, 8, v1
  s_nop 0
  v_cndmask_b32 v89, v13, v10, vcc
  s_lshl_b32 s3, s57, 14
  s_add_u32 s3, s3, 98304
  v_add_u32 v16, s3, v2
  v_and_b32 v10, 3, v1
  v_mul_u32_u24 v10, 1408, v10
  v_add_u32 v90, s3, v10
  v_add_u32 v17, 16, v247
  v_mov_b32 v204, v13
  v_mov_b32 v205, v13
  v_mov_b32 v206, v13
  v_mov_b32 v207, v13
  v_mov_b32 v208, v13
  v_mov_b32 v209, v13
  v_mov_b32 v210, v13
  v_mov_b32 v211, v13
  v_mov_b32 v212, v13
  v_mov_b32 v213, v13
  v_mov_b32 v200, v13
  v_mov_b32 v201, v13
  v_mov_b32 v202, v13
  v_mov_b32 v203, v13
  v_mov_b32 v204, v13
  v_mov_b32 v205, v13
  v_mov_b32 v206, v13
  v_mov_b32 v207, v13
  s_cmp_lg_u32 s98, 0
  s_cbranch_scc1 f_lb
  s_mov_b32 s64, 0x100000
f_c11:
  ds_read_b32 v248, v17 offset:0
  s_sub_u32 s64, s64, 1
  s_waitcnt lgkmcnt(0)
  v_cmp_gt_u32 vcc, 11, v248
  s_cmp_eq_u32 s64, 0
  s_cbranch_scc1 f_c11x
  s_cbranch_vccnz f_c11
f_c11x:
  ds_read_b128 v[92:95], v16 offset:10752
  ds_read_b128 v[96:99], v16 offset:11776
  ds_read_b128 v[100:103], v16 offset:12800
  ds_read_b128 v[104:107], v16 offset:13824
  ds_read_b128 v[108:111], v16 offset:14848
  ds_read_b128 v[112:115], v16 offset:15872
  s_waitcnt lgkmcnt(5)
  buffer_store_dwordx4 v[92:95], v72, s[12:15], 0 offen sc1
  s_waitcnt lgkmcnt(4)
  buffer_store_dwordx4 v[96:99], v73, s[12:15], 0 offen sc1
  s_waitcnt lgkmcnt(3)
  buffer_store_dwordx4 v[100:103], v74, s[12:15], 0 offen sc1
  s_waitcnt lgkmcnt(2)
  buffer_store_dwordx4 v[104:107], v75, s[12:15], 0 offen sc1
  s_waitcnt lgkmcnt(1)
  buffer_store_dwordx4 v[108:111], v76, s[12:15], 0 offen sc1
  s_waitcnt lgkmcnt(0)
  buffer_store_dwordx4 v[112:115], v77, s[12:15], 0 offen sc1
  s_mov_b32 s64, 0x100000
f_c12:
  ds_read_b32 v248, v17 offset:0
  s_sub_u32 s64, s64, 1
  s_waitcnt lgkmcnt(0)
  v_cmp_gt_u32 vcc, 12, v248
  s_cmp_eq_u32 s64, 0
  s_cbranch_scc1 f_c12x
  s_cbranch_vccnz f_c12
f_c12x:
  ds_read_b32 v18, v90 offset:12156
  ds_read_b128 v[116:119], v16 offset:0
  ds_read_b128 v[120:123], v16 offset:1024
  ds_read_b128 v[124:127], v16 offset:2048
  ds_read_b128 v[128:131], v16 offset:3072
  ds_read_b128 v[132:135], v16 offset:4096
  s_waitcnt lgkmcnt(4)
  buffer_store_dwordx4 v[116:119], v78, s[12:15], 0 offen sc1
  s_waitcnt lgkmcnt(3)
  buffer_store_dwordx4 v[120:123], v79, s[12:15], 0 offen sc1
  s_waitcnt lgkmcnt(2)
  buffer_store_dwordx4 v[124:127], v80, s[12:15], 0 offen sc1
  s_waitcnt lgkmcnt(1)
  buffer_store_dwordx4 v[128:131], v81, s[12:15], 0 offen sc1
  s_waitcnt lgkmcnt(0)
  buffer_store_dwordx4 v[132:135], v82, s[12:15], 0 offen sc1
  buffer_store_dword v18, v89, s[12:15], s48 offen sc1
  s_mov_b32 s64, 0x100000
f_c13:
  ds_read_b32 v248, v17 offset:0
  s_sub_u32 s64, s64, 1
  s_waitcnt lgkmcnt(0)
  v_cmp_gt_u32 vcc, 13, v248
  s_cmp_eq_u32 s64, 0
  s_cbranch_scc1 f_c13x
  s_cbranch_vccnz f_c13
f_c13x:
  ds_read_b128 v[136:139], v16 offset:7936
  ds_read_b128 v[140:143], v16 offset:8960
  ds_read_b128 v[144:147], v16 offset:9984
  s_waitcnt lgkmcnt(2)
  buffer_store_dwordx4 v[136:139], v83, s[12:15], 0 offen sc1
  s_waitcnt lgkmcnt(1)
  buffer_store_dwordx4 v[140:143], v84, s[12:15], 0 offen sc1
  s_waitcnt lgkmcnt(0)
  buffer_store_dwordx4 v[144:147], v85, s[12:15], 0 offen sc1
  v_mov_b32 v9, 1
  s_mov_b64 exec, 1
  ds_add_u32 v49, v9 offset:0
  s_mov_b64 exec, -1
  s_waitcnt vmcnt(3)
  v_mov_b32 v9, 1
  s_mov_b64 exec, 1
  ds_add_rtn_u32 v8, v49, v9 offset:32
  s_mov_b64 exec, -1
  s_lshl_b32 s3, s18, 4
  s_add_u32 s3, s3, s17
  s_lshl_b32 s3, s3, 8
  s_add_u32 s3, s3, 17825792
  s_waitcnt lgkmcnt(0)
  v_readfirstlane_b32 s44, v8
  v_mov_b32 v8, s19
  v_mov_b32 v9, 0
  s_nop 1
  s_cmp_lg_u32 s44, 3
  s_cbranch_scc1 f_lnf
  buffer_store_dword v8, v9, s[12:15], s3 offen sc1
f_lnf:
  s_waitcnt vmcnt(1)
  s_cmp_eq_u32 s44, 3
  s_cbranch_scc1 f_lq1
  s_waitcnt vmcnt(0)
f_lq1:
  v_mov_b32 v9, 1
  s_mov_b64 exec, 1
  ds_add_rtn_u32 v8, v49, v9 offset:40
  s_mov_b64 exec, -1
  s_lshl_b32 s3, s18, 4
  s_add_u32 s3, s3, s17
  s_lshl_b32 s3, s3, 8
  s_add_u32 s3, s3, 17956864
  s_waitcnt lgkmcnt(0)
  v_readfirstlane_b32 s44, v8
  v_mov_b32 v8, s19
  v_mov_b32 v9, 0
  s_nop 1
  s_cmp_lg_u32 s44, 3
  s_cbranch_scc1 f_lnq
  buffer_store_dword v8, v9, s[12:15], s3 offen sc1
f_lnq:
  s_branch f_attn
f_lb:
  s_mov_b32 s64, 0x100000
  s_branch f_c13by
f_c13b:
  s_sleep 1
f_c13by:
  ds_read_b32 v248, v246 offset:16
  s_sub_u32 s64, s64, 1
  s_waitcnt lgkmcnt(0)
  v_cmp_gt_u32 vcc, 13, v248
  s_cmp_eq_u32 s64, 0
  s_cbranch_scc1 f_c13bx
  s_cbranch_vccnz f_c13b
f_c13bx:
  v_subrev_u32 v10, 256, v0
  s_mov_b32 s43, 0x271
  s_lshl_b32 s3, s18, 6
  s_add_u32 s3, s3, s17
  s_mul_i32 s3, s3, 1680
  s_add_u32 s3, s3, 11534336
  v_min_u32 v11, 419, v10
  v_cmp_lt_u32 vcc, 314, v11
  v_lshlrev_b32 v11, 4, v11
  v_mov_b32 v12, 98304
  v_mov_b32 v13, 104016
  v_cndmask_b32 v12, v12, v13, vcc
  v_add_u32 v11, v11, v12
  ds_read_b128 v[92:95], v11 offset:0
  ds_read_b128 v[96:99], v11 offset:16384
  ds_read_b128 v[100:103], v11 offset:32768
  ds_read_b128 v[104:107], v11 offset:49152
  v_mul_u32_u24 v12, s43, v10
  v_lshrrev_b32 v12, 16, v12
  v_mul_u32_u24 v12, 25200, v12
  v_lshl_add_u32 v12, v10, 4, v12
  v_mov_b32 v13, 2130706432
  v_cmp_gt_u32 vcc, 420, v10
  s_nop 1
  v_cndmask_b32 v14, v13, v12, vcc
  v_add_u32 v10, 256, v10
  v_min_u32 v11, 419, v10
  v_cmp_lt_u32 vcc, 314, v11
  v_lshlrev_b32 v11, 4, v11
  v_mov_b32 v12, 98304
  v_mov_b32 v13, 104016
  v_cndmask_b32 v12, v12, v13, vcc
  v_add_u32 v11, v11, v12
  ds_read_b128 v[108:111], v11 offset:0
  ds_read_b128 v[112:115], v11 offset:16384
  ds_read_b128 v[116:119], v11 offset:32768
  ds_read_b128 v[120:123], v11 offset:49152
  v_mul_u32_u24 v12, s43, v10
  v_lshrrev_b32 v12, 16, v12
  v_mul_u32_u24 v12, 25200, v12
  v_lshl_add_u32 v12, v10, 4, v12
  v_mov_b32 v13, 2130706432
  v_cmp_gt_u32 vcc, 420, v10
  s_nop 1
  v_cndmask_b32 v15, v13, v12, vcc
  s_waitcnt lgkmcnt(4)
  v_pk_add_f32 v[92:93], v[92:93], v[96:97]
  v_pk_add_f32 v[100:101], v[100:101], v[104:105]
  v_pk_add_f32 v[94:95], v[94:95], v[98:99]
  v_pk_add_f32 v[102:103], v[102:103], v[106:107]
  v_pk_add_f32 v[92:93], v[92:93], v[100:101]
  v_pk_add_f32 v[94:95], v[94:95], v[102:103]
  s_waitcnt lgkmcnt(0)
  v_pk_add_f32 v[108:109], v[108:109], v[112:113]
  v_pk_add_f32 v[116:117], v[116:117], v[120:121]
  v_pk_add_f32 v[110:111], v[110:111], v[114:115]
  v_pk_add_f32 v[118:119], v[118:119], v[122:123]
  v_pk_add_f32 v[108:109], v[108:109], v[116:117]
  v_pk_add_f32 v[110:111], v[110:111], v[118:119]
  ds_read_b128 v[188:191], v16 offset:5120
  ds_read_b128 v[192:195], v16 offset:6144
  ds_read_b128 v[196:199], v16 offset:7168
  ds_read_b128 v[200:203], v16 offset:8192
  ds_read_b128 v[204:207], v16 offset:9216
  ds_read_b128 v[208:211], v16 offset:10240
  v_mov_b32 v180, v92
  v_mov_b32 v181, v93
  v_mov_b32 v182, v94
  v_mov_b32 v183, v95
  v_mov_b32 v76, v14
  v_mov_b32 v184, v108
  v_mov_b32 v185, v109
  v_mov_b32 v186, v110
  v_mov_b32 v187, v111
  v_mov_b32 v77, v15
  v_mov_b32 v78, v83
  v_mov_b32 v79, v84
  v_mov_b32 v80, v85
  v_mov_b32 v81, v86
  v_mov_b32 v82, v87
  v_mov_b32 v83, v88
  s_mov_b32 s99, s3
  s_waitcnt lgkmcnt(0)
  v_mov_b32 v9, 1
  s_mov_b64 exec, 1
  ds_add_u32 v49, v9 offset:0
  s_mov_b64 exec, -1
  s_cmp_lg_u32 s16, 4
  s_cbranch_scc1 f_attn
  v_and_b32 v8, 15, v1
  v_lshlrev_b32 v8, 8, v8
  s_lshl_b32 s3, s17, 8
  s_add_u32 s3, s3, 0x20000
  v_mov_b32 v9, s3
  v_cmp_gt_u32 vcc, 32, v1
  s_nop 1
  v_cndmask_b32 v8, v9, v8, vcc
  s_lshl_b32 s65, s18, 12
  s_add_u32 s65, s65, 17825792
  s_mov_b32 s64, 0x20000
  s_mov_b32 s66, 0
f_cb_p:
  buffer_load_dword v10, v8, s[12:15], s65 offen sc1
  s_waitcnt vmcnt(0)
  v_cmp_ne_u32 vcc, s19, v10
  s_sub_u32 s64, s64, 1
  s_cmp_eq_u32 s64, 0
  s_nop 1
  s_cselect_b64 vcc, 0, vcc
  s_or_b32 s67, vcc_hi, s66
  s_cmp_lg_u32 s67, 0
  s_cbranch_scc1 f_cb_n
  s_mov_b32 s66, 1
  v_mov_b32 v9, 1
  s_mov_b64 exec, 1
  ds_add_u32 v49, v9 offset:52
  s_mov_b64 exec, -1
f_cb_n:
  s_cbranch_vccz f_cb_d
  s_sleep 1
  s_branch f_cb_p
f_cb_d:
  v_mov_b32 v9, 1
  s_mov_b64 exec, 1
  ds_add_u32 v49, v9 offset:28
  s_mov_b64 exec, -1
  s_branch f_attn
f_comp:
  v_and_b32 v10, 15, v1
  v_lshrrev_b32 v11, 4, v1
  v_lshrrev_b32 v12, 2, v10
  v_and_b32 v13, 3, v10
  v_lshl_add_u32 v14, v12, 3, v13
  v_bfe_u32 v15, v10, 1, 1
  v_lshl_add_u32 v15, v12, 1, v15
  v_xor_b32 v15, v15, v11
  v_lshlrev_b32 v15, 4, v15
  v_lshl_add_u32 v15, v14, 7, v15
  s_lshl_b32 s3, s57, 12
  v_add_u32 v50, s3, v15
  v_xor_b32 v51, 64, v50
  v_lshrrev_b32 v15, 2, v1
  v_mul_u32_u24 v15, 480, v15
  v_mul_u32_u24 v16, 40, v13
  v_add_u32 v52, v15, v16
  v_lshl_add_u32 v53, v13, 3, v15
  v_and_b32 v246, 3, v1
  v_lshlrev_b32 v246, 2, v246
  v_add_u32 v246, 162368, v246
  s_lshl_b32 s3, s57, 2
  s_add_u32 s3, s3, 162384
  v_mov_b32 v247, s3
  v_mov_b32 v49, 163776
  s_waitcnt lgkmcnt(0)
  s_cmp_eq_u32 s98, 0
  s_cselect_b32 s20, s40, s42
  s_cselect_b32 s21, s41, s43
  s_mov_b32 s22, 819200
  s_mov_b32 s23, 0x20000
  s_mov_b32 s14, 20971520
  s_mov_b32 s15, 0x20000
  s_mov_b32 s24, s44
  s_mov_b32 s25, s45
  s_mov_b32 s26, 5242880
  s_mov_b32 s27, 0x20000
  s_mov_b32 s28, s46
  s_mov_b32 s29, s47
  s_mov_b32 s30, 256
  s_mov_b32 s31, 0x20000
  s_cmp_lg_u32 s16, 0
  s_cbranch_scc1 f_c1
  v_mov_b32 v9, 0
  v_and_b32 v8, 15, v1
  v_lshlrev_b32 v8, 2, v8
  v_add_u32 v10, 162368, v8
  v_add_u32 v8, 163776, v8
  ds_write_b32 v8, v9
  ds_write_b32 v10, v9
  s_cmp_lg_u32 s2, 0
  s_cbranch_scc1 f_c1
  s_memrealtime s[64:65]
  s_waitcnt lgkmcnt(0)
  s_or_b32 s64, s64, 1
  v_mov_b32 v8, s64
  buffer_store_dword v8, v9, s[28:31], 0 offen sc1
f_c1:
  s_waitcnt lgkmcnt(0)
  s_barrier
  v_lshlrev_b32 v2, 4, v1
  v_and_b32 v8, 31, v1
  v_lshrrev_b32 v9, 5, v1
  v_mul_u32_u24 v4, 336, v9
  v_lshl_add_u32 v4, v8, 4, v4
  v_mov_b32 v10, 2130706432
  v_cmp_gt_u32 vcc, 21, v8
  s_nop 1
  v_cndmask_b32 v4, v10, v4, vcc
  v_lshlrev_b32 v3, 3, v8
  v_mov_b32 v10, 576
  v_cmp_gt_u32 vcc, 32, v1
  s_nop 1
  v_cndmask_b32 v3, v10, v3, vcc
  v_mov_b32 v5, 0xdddddddd
  s_lshr_b32 s58, s16, 2
  s_lshl_b32 s59, s18, 1
  s_add_u32 s59, s59, s98
  s_lshl_b32 s59, s59, 1
  s_add_u32 s59, s59, s58
  s_lshl_b32 s3, s17, 2
  s_add_u32 s3, s3, s57
  s_mov_b32 s55, s3
  s_mul_i32 s3, s3, 40960
  v_lshrrev_b32 v10, 4, v8
  v_mul_u32_u24 v10, 20480, v10
  v_add_u32 v10, s3, v10
  v_and_b32 v11, 15, v8
  v_lshl_add_u32 v6, v11, 4, v10
  v_lshl_add_u32 v6, v9, 8, v6
  s_lshr_b32 s3, s59, 1
  s_lshl_b32 s3, s3, 9
  s_lshl_b32 s62, s58, 13
  s_add_u32 s3, s3, s62
  v_add_u32 v6, s3, v6
  v_lshl_add_u32 v10, v11, 3, v10
  s_lshr_b32 s3, s59, 1
  s_lshl_b32 s3, s3, 7
  s_lshl_b32 s62, s58, 11
  s_add_u32 s3, s3, s62
  s_add_u32 s3, s3, 16384
  v_add_u32 v10, s3, v10
  v_mov_b32 v11, 2130706432
  v_cndmask_b32 v7, v11, v10, vcc
  s_mul_i32 s63, s59, 172032
  s_mov_b32 s60, 1069066811
  s_mov_b32 s61, s60
  s_mov_b32 s96, 897988541
  s_mov_b32 s97, s96
  s_mov_b32 s62, 0x07060302
  v_mov_b32 v112, 0
  v_mov_b32 v113, 0
  v_mov_b32 v114, 0
  v_mov_b32 v115, 0
  v_mov_b32 v116, 0
  v_mov_b32 v117, 0
  v_mov_b32 v118, 0
  v_mov_b32 v119, 0
  v_mov_b32 v120, 0
  v_mov_b32 v121, 0
  v_mov_b32 v122, 0
  v_mov_b32 v123, 0
  v_mov_b32 v124, 0
  v_mov_b32 v125, 0
  v_mov_b32 v126, 0
  v_mov_b32 v127, 0
  v_mov_b32 v128, 0
  v_mov_b32 v129, 0
  v_mov_b32 v130, 0
  v_mov_b32 v131, 0
  v_mov_b32 v132, 0
  v_mov_b32 v133, 0
  v_mov_b32 v134, 0
  v_mov_b32 v135, 0
  v_mov_b32 v136, 0
  v_mov_b32 v137, 0
  v_mov_b32 v138, 0
  v_mov_b32 v139, 0
  v_mov_b32 v140, 0
  v_mov_b32 v141, 0
  v_mov_b32 v142, 0
  v_mov_b32 v143, 0
  v_mov_b32 v144, 0
  v_mov_b32 v145, 0
  v_mov_b32 v146, 0
  v_mov_b32 v147, 0
  v_mov_b32 v148, 0
  v_mov_b32 v149, 0
  v_mov_b32 v150, 0
  v_mov_b32 v151, 0
  v_mov_b32 v152, 0
  v_mov_b32 v153, 0
  v_mov_b32 v154, 0
  v_mov_b32 v155, 0
  v_mov_b32 v156, 0
  v_mov_b32 v157, 0
  v_mov_b32 v158, 0
  v_mov_b32 v159, 0
  v_mov_b32 v160, 0
  v_mov_b32 v161, 0
  v_mov_b32 v162, 0
  v_mov_b32 v163, 0
  v_mov_b32 v164, 0
  v_mov_b32 v165, 0
  v_mov_b32 v166, 0
  v_mov_b32 v167, 0
  v_mov_b32 v168, 0
  v_mov_b32 v169, 0
  v_mov_b32 v170, 0
  v_mov_b32 v171, 0
  v_mov_b32 v172, 0
  v_mov_b32 v173, 0
  v_mov_b32 v174, 0
  v_mov_b32 v175, 0
  v_mov_b32 v176, 0
  v_mov_b32 v177, 0
  v_mov_b32 v178, 0
  v_mov_b32 v179, 0
  v_mov_b32 v180, 0
  v_mov_b32 v181, 0
  v_mov_b32 v182, 0
  v_mov_b32 v183, 0
  v_mov_b32 v184, 0
  v_mov_b32 v185, 0
  v_mov_b32 v186, 0
  v_mov_b32 v187, 0
  v_mov_b32 v188, 0
  v_mov_b32 v189, 0
  v_mov_b32 v190, 0
  v_mov_b32 v191, 0
  v_mov_b32 v192, 0
  v_mov_b32 v193, 0
  v_mov_b32 v194, 0
  v_mov_b32 v195, 0
  v_mov_b32 v196, 0
  v_mov_b32 v197, 0
  v_mov_b32 v198, 0
  v_mov_b32 v199, 0
  v_mov_b32 v200, 0
  v_mov_b32 v201, 0
  v_mov_b32 v202, 0
  v_mov_b32 v203, 0
  v_mov_b32 v204, 0
  v_mov_b32 v205, 0
  v_mov_b32 v206, 0
  v_mov_b32 v207, 0
  v_mov_b32 v208, 0
  v_mov_b32 v209, 0
  v_mov_b32 v210, 0
  v_mov_b32 v211, 0
  v_mov_b32 v212, 0
  v_mov_b32 v213, 0
  v_mov_b32 v214, 0
  v_mov_b32 v215, 0
  v_mov_b32 v216, 0
  v_mov_b32 v217, 0
  v_mov_b32 v218, 0
  v_mov_b32 v219, 0
  v_mov_b32 v220, 0
  v_mov_b32 v221, 0
  v_mov_b32 v222, 0
  v_mov_b32 v223, 0
  v_mov_b32 v224, 0
  v_mov_b32 v225, 0
  v_mov_b32 v226, 0
  v_mov_b32 v227, 0
  v_mov_b32 v228, 0
  v_mov_b32 v229, 0
  v_mov_b32 v230, 0
  v_mov_b32 v231, 0
  s_mov_b32 s45, 0
  s_mov_b32 s40, 0
  s_mov_b32 s42, 4294868992
  s_mov_b32 s43, 49152
  s_mov_b32 s64, 0x100000
f_s0:
  ds_read_b32 v248, v246 offset:0
  s_sub_u32 s64, s64, 1
  s_waitcnt lgkmcnt(0)
  v_cmp_ge_u32 vcc, 0, v248
  s_cmp_eq_u32 s64, 0
  s_cbranch_scc1 f_s0x
  s_cbranch_vccnz f_s0
f_s0x:
  s_cmp_lg_u32 s98, 0
  s_cbranch_scc1 f_gb
  ds_read_b64_tr_b16 v[72:73], v52 offset:0
  ds_read_b64_tr_b16 v[74:75], v52 offset:7680
  ds_read_b64_tr_b16 v[76:77], v52 offset:8
  ds_read_b64_tr_b16 v[78:79], v52 offset:7688
  ds_read_b128 v[56:59], v50 offset:32768
  ds_read_b128 v[60:63], v50 offset:33280
  ds_read_b64_tr_b16 v[80:81], v52 offset:16
  ds_read_b64_tr_b16 v[82:83], v52 offset:7696
  ds_read_b64_tr_b16 v[84:85], v52 offset:24
  ds_read_b64_tr_b16 v[86:87], v52 offset:7704
  ds_read_b64_tr_b16 v[88:89], v52 offset:32
  ds_read_b64_tr_b16 v[90:91], v52 offset:7712
  ds_read_b64_tr_b16 v[92:93], v52 offset:160
  ds_read_b64_tr_b16 v[94:95], v52 offset:7840
  ds_read_b64_tr_b16 v[96:97], v52 offset:168
  ds_read_b64_tr_b16 v[98:99], v52 offset:7848
.p2align 6
f_ga_loop:
  s_waitcnt lgkmcnt(10)
  v_mfma_f32_16x16x32_bf16 v[112:115], v[72:75], v[56:59], v[112:115]
  ds_read_b64_tr_b16 v[100:101], v52 offset:176
  v_mfma_f32_16x16x32_bf16 v[116:119], v[72:75], v[60:63], v[116:119]
  ds_read_b64_tr_b16 v[102:103], v52 offset:7856
  v_mfma_f32_16x16x32_bf16 v[120:123], v[76:79], v[56:59], v[120:123]
  ds_read_b64_tr_b16 v[104:105], v52 offset:184
  v_mfma_f32_16x16x32_bf16 v[124:127], v[76:79], v[60:63], v[124:127]
  ds_read_b64_tr_b16 v[106:107], v52 offset:7864
  s_waitcnt lgkmcnt(10)
  v_mfma_f32_16x16x32_bf16 v[128:131], v[80:83], v[56:59], v[128:131]
  ds_read_b64_tr_b16 v[108:109], v52 offset:192
  v_mfma_f32_16x16x32_bf16 v[132:135], v[80:83], v[60:63], v[132:135]
  ds_read_b64_tr_b16 v[110:111], v52 offset:7872
  v_mfma_f32_16x16x32_bf16 v[136:139], v[84:87], v[56:59], v[136:139]
  ds_read_b64_tr_b16 v[72:73], v53 offset:320
  v_mfma_f32_16x16x32_bf16 v[140:143], v[84:87], v[60:63], v[140:143]
  ds_read_b64_tr_b16 v[74:75], v53 offset:8000
  s_waitcnt lgkmcnt(10)
  v_mfma_f32_16x16x32_bf16 v[144:147], v[88:91], v[56:59], v[144:147]
  ds_read_b64_tr_b16 v[76:77], v53 offset:360
  ds_read_b128 v[64:67], v51 offset:32768
  v_mfma_f32_16x16x32_bf16 v[148:151], v[88:91], v[60:63], v[148:151]
  ds_read_b64_tr_b16 v[78:79], v53 offset:8040
  v_mfma_f32_16x16x32_bf16 v[152:155], v[92:95], v[56:59], v[152:155]
  ds_read_b64_tr_b16 v[80:81], v53 offset:400
  ds_read_b128 v[68:71], v51 offset:33280
  v_mfma_f32_16x16x32_bf16 v[156:159], v[92:95], v[60:63], v[156:159]
  ds_read_b64_tr_b16 v[82:83], v53 offset:8080
  s_waitcnt lgkmcnt(12)
  v_mfma_f32_16x16x32_bf16 v[160:163], v[96:99], v[56:59], v[160:163]
  ds_read_b64_tr_b16 v[84:85], v53 offset:440
  v_mfma_f32_16x16x32_bf16 v[164:167], v[96:99], v[60:63], v[164:167]
  ds_read_b64_tr_b16 v[86:87], v53 offset:8120
  v_mfma_f32_16x16x32_bf16 v[168:171], v[100:103], v[56:59], v[168:171]
  ds_read_b64_tr_b16 v[88:89], v52 offset:352
  v_mfma_f32_16x16x32_bf16 v[172:175], v[100:103], v[60:63], v[172:175]
  ds_read_b64_tr_b16 v[90:91], v52 offset:8032
  s_waitcnt lgkmcnt(12)
  v_mfma_f32_16x16x32_bf16 v[176:179], v[104:107], v[56:59], v[176:179]
  ds_read_b64_tr_b16 v[92:93], v52 offset:15360
  v_mfma_f32_16x16x32_bf16 v[180:183], v[104:107], v[60:63], v[180:183]
  ds_read_b64_tr_b16 v[94:95], v52 offset:23040
  v_mfma_f32_16x16x32_bf16 v[184:187], v[108:111], v[56:59], v[184:187]
  ds_read_b64_tr_b16 v[96:97], v52 offset:15368
  v_mfma_f32_16x16x32_bf16 v[188:191], v[108:111], v[60:63], v[188:191]
  ds_read_b64_tr_b16 v[98:99], v52 offset:23048
  s_waitcnt lgkmcnt(11)
  v_mfma_f32_16x16x32_bf16 v[192:195], v[56:59], v[72:75], v[192:195]
  ds_read_b64_tr_b16 v[100:101], v52 offset:15376
  v_mfma_f32_16x16x32_bf16 v[196:199], v[60:63], v[72:75], v[196:199]
  ds_read_b64_tr_b16 v[102:103], v52 offset:23056
  v_mfma_f32_16x16x32_bf16 v[200:203], v[56:59], v[76:79], v[200:203]
  ds_read_b64_tr_b16 v[104:105], v52 offset:15384
  v_mfma_f32_16x16x32_bf16 v[204:207], v[60:63], v[76:79], v[204:207]
  ds_read_b64_tr_b16 v[106:107], v52 offset:23064
  s_waitcnt lgkmcnt(10)
  v_mfma_f32_16x16x32_bf16 v[208:211], v[56:59], v[80:83], v[208:211]
  ds_read_b64_tr_b16 v[108:109], v52 offset:15392
  v_mfma_f32_16x16x32_bf16 v[212:215], v[60:63], v[80:83], v[212:215]
  ds_read_b64_tr_b16 v[110:111], v52 offset:23072
  v_mfma_f32_16x16x32_bf16 v[216:219], v[56:59], v[84:87], v[216:219]
  ds_read_b64_tr_b16 v[72:73], v52 offset:15520
  v_mfma_f32_16x16x32_bf16 v[220:223], v[60:63], v[84:87], v[220:223]
  ds_read_b64_tr_b16 v[74:75], v52 offset:23200
  s_waitcnt lgkmcnt(10)
  v_mfma_f32_16x16x32_bf16 v[224:227], v[56:59], v[88:91], v[224:227]
  ds_read_b64_tr_b16 v[76:77], v52 offset:15528
  v_mfma_f32_16x16x32_bf16 v[228:231], v[60:63], v[88:91], v[228:231]
  ds_read_b64_tr_b16 v[78:79], v52 offset:23208
  v_mfma_f32_16x16x32_bf16 v[112:115], v[92:95], v[64:67], v[112:115]
  ds_read_b64_tr_b16 v[80:81], v52 offset:15536
  v_mfma_f32_16x16x32_bf16 v[116:119], v[92:95], v[68:71], v[116:119]
  ds_read_b64_tr_b16 v[82:83], v52 offset:23216
  s_waitcnt lgkmcnt(10)
  v_mfma_f32_16x16x32_bf16 v[120:123], v[96:99], v[64:67], v[120:123]
  ds_read_b64_tr_b16 v[84:85], v52 offset:15544
  s_add_u32 s45, s45, 1
  v_mfma_f32_16x16x32_bf16 v[124:127], v[96:99], v[68:71], v[124:127]
  ds_read_b64_tr_b16 v[86:87], v52 offset:23224
  s_add_u32 s40, s40, 49152
  v_mfma_f32_16x16x32_bf16 v[128:131], v[100:103], v[64:67], v[128:131]
  ds_read_b64_tr_b16 v[88:89], v52 offset:15552
  s_cmp_eq_u32 s40, 147456
  v_mfma_f32_16x16x32_bf16 v[132:135], v[100:103], v[68:71], v[132:135]
  ds_read_b64_tr_b16 v[90:91], v52 offset:23232
  s_cselect_b32 s41, s42, s43
  s_waitcnt lgkmcnt(10)
  v_mfma_f32_16x16x32_bf16 v[136:139], v[104:107], v[64:67], v[136:139]
  ds_read_b64_tr_b16 v[92:93], v53 offset:15680
  s_cselect_b32 s40, 0, s40
  v_mfma_f32_16x16x32_bf16 v[140:143], v[104:107], v[68:71], v[140:143]
  ds_read_b64_tr_b16 v[94:95], v53 offset:23360
  v_mfma_f32_16x16x32_bf16 v[144:147], v[108:111], v[64:67], v[144:147]
  ds_read_b64_tr_b16 v[96:97], v53 offset:15720
  v_mfma_f32_16x16x32_bf16 v[148:151], v[108:111], v[68:71], v[148:151]
  ds_read_b64_tr_b16 v[98:99], v53 offset:23400
  s_waitcnt lgkmcnt(10)
  v_mfma_f32_16x16x32_bf16 v[152:155], v[72:75], v[64:67], v[152:155]
  ds_read_b32 v248, v246
  ds_read_b64_tr_b16 v[100:101], v53 offset:15760
  v_mfma_f32_16x16x32_bf16 v[156:159], v[72:75], v[68:71], v[156:159]
  ds_read_b64_tr_b16 v[102:103], v53 offset:23440
  v_mfma_f32_16x16x32_bf16 v[160:163], v[76:79], v[64:67], v[160:163]
  ds_read_b64_tr_b16 v[104:105], v53 offset:15800
  v_mfma_f32_16x16x32_bf16 v[164:167], v[76:79], v[68:71], v[164:167]
  ds_read_b64_tr_b16 v[106:107], v53 offset:23480
  s_waitcnt lgkmcnt(11)
  v_mfma_f32_16x16x32_bf16 v[168:171], v[80:83], v[64:67], v[168:171]
  ds_read_b64_tr_b16 v[108:109], v52 offset:15712
  v_mfma_f32_16x16x32_bf16 v[172:175], v[80:83], v[68:71], v[172:175]
  ds_read_b64_tr_b16 v[110:111], v52 offset:23392
  v_mfma_f32_16x16x32_bf16 v[176:179], v[84:87], v[64:67], v[176:179]
  v_add_u32 v50, s41, v50
  v_add_u32 v52, s41, v52
  v_mfma_f32_16x16x32_bf16 v[180:183], v[84:87], v[68:71], v[180:183]
  v_add_u32 v51, s41, v51
  v_add_u32 v53, s41, v53
  s_waitcnt lgkmcnt(9)
  v_mfma_f32_16x16x32_bf16 v[184:187], v[88:91], v[64:67], v[184:187]
  s_waitcnt lgkmcnt(6)
  v_cmp_ge_u32 vcc, s45, v248
  v_mfma_f32_16x16x32_bf16 v[188:191], v[88:91], v[68:71], v[188:191]
  v_mov_b32 v249, s45
  s_cbranch_vccz f_ga_ok
  s_mov_b32 s64, 0x100000
f_ga_s:
  ds_read_b32 v248, v246 offset:0
  s_sub_u32 s64, s64, 1
  s_waitcnt lgkmcnt(0)
  v_cmp_ge_u32 vcc, s45, v248
  s_cmp_eq_u32 s64, 0
  s_cbranch_scc1 f_ga_sx
  s_cbranch_vccnz f_ga_s
f_ga_sx:
f_ga_ok:
  v_mfma_f32_16x16x32_bf16 v[192:195], v[64:67], v[92:95], v[192:195]
  ds_read_b64_tr_b16 v[72:73], v52 offset:0
  ds_read_b64_tr_b16 v[74:75], v52 offset:7680
  v_mfma_f32_16x16x32_bf16 v[196:199], v[68:71], v[92:95], v[196:199]
  ds_read_b64_tr_b16 v[76:77], v52 offset:8
  ds_read_b64_tr_b16 v[78:79], v52 offset:7688
  s_waitcnt lgkmcnt(8)
  v_mfma_f32_16x16x32_bf16 v[200:203], v[64:67], v[96:99], v[200:203]
  ds_read_b128 v[56:59], v50 offset:32768
  ds_read_b128 v[60:63], v50 offset:33280
  v_mfma_f32_16x16x32_bf16 v[204:207], v[68:71], v[96:99], v[204:207]
  ds_read_b64_tr_b16 v[80:81], v52 offset:16
  ds_read_b64_tr_b16 v[82:83], v52 offset:7696
  v_mfma_f32_16x16x32_bf16 v[208:211], v[64:67], v[100:103], v[208:211]
  ds_read_b64_tr_b16 v[84:85], v52 offset:24
  ds_read_b64_tr_b16 v[86:87], v52 offset:7704
  v_mfma_f32_16x16x32_bf16 v[212:215], v[68:71], v[100:103], v[212:215]
  ds_read_b64_tr_b16 v[88:89], v52 offset:32
  ds_read_b64_tr_b16 v[90:91], v52 offset:7712
  s_waitcnt lgkmcnt(12)
  v_mfma_f32_16x16x32_bf16 v[216:219], v[64:67], v[104:107], v[216:219]
  ds_read_b64_tr_b16 v[92:93], v52 offset:160
  ds_write_b32 v247, v249
  v_mfma_f32_16x16x32_bf16 v[220:223], v[68:71], v[104:107], v[220:223]
  ds_read_b64_tr_b16 v[94:95], v52 offset:7840
  v_mfma_f32_16x16x32_bf16 v[224:227], v[64:67], v[108:111], v[224:227]
  ds_read_b64_tr_b16 v[96:97], v52 offset:168
  v_mfma_f32_16x16x32_bf16 v[228:231], v[68:71], v[108:111], v[228:231]
  ds_read_b64_tr_b16 v[98:99], v52 offset:7848
  s_cmp_lt_u32 s45, 10
  s_cbranch_scc1 f_ga_loop
  s_waitcnt lgkmcnt(0)
  ds_read_b32 v20, v49 offset:36
  v_and_b32 v10, 15, v1
  v_lshrrev_b32 v11, 4, v1
  v_lshrrev_b32 v12, 2, v10
  v_and_b32 v13, 3, v10
  v_lshl_add_u32 v14, v12, 3, v13
  s_lshl_b32 s43, s57, 14
  s_add_u32 s43, s43, 98304
  v_cvt_pk_bf16_f32 v80, v192, v193
  v_cvt_pk_bf16_f32 v81, v194, v195
  v_cvt_pk_bf16_f32 v82, v196, v197
  v_cvt_pk_bf16_f32 v83, v198, v199
  v_cvt_pk_bf16_f32 v84, v200, v201
  v_cvt_pk_bf16_f32 v85, v202, v203
  v_cvt_pk_bf16_f32 v86, v204, v205
  v_cvt_pk_bf16_f32 v87, v206, v207
  v_cvt_pk_bf16_f32 v88, v208, v209
  v_cvt_pk_bf16_f32 v89, v210, v211
  v_cvt_pk_bf16_f32 v90, v212, v213
  v_cvt_pk_bf16_f32 v91, v214, v215
  v_cvt_pk_bf16_f32 v92, v216, v217
  v_cvt_pk_bf16_f32 v93, v218, v219
  v_cvt_pk_bf16_f32 v94, v220, v221
  v_cvt_pk_bf16_f32 v95, v222, v223
  v_cvt_pk_bf16_f32 v96, v224, v225
  v_cvt_pk_bf16_f32 v97, v226, v227
  v_cvt_pk_bf16_f32 v98, v228, v229
  v_cvt_pk_bf16_f32 v99, v230, v231
  v_mul_u32_u24 v15, 336, v11
  v_add_u32 v15, s43, v15
  v_lshl_add_u32 v16, v10, 4, v15
  v_mul_u32_u24 v17, 1408, v12
  v_lshl_add_u32 v17, v13, 4, v17
  v_add_u32 v17, v17, v15
  v_mul_u32_u24 v18, 1408, v13
  v_add_u32 v18, v18, v15
  v_mov_b32 v100, 0x3f803f80
  v_mov_b32 v101, 0x3f803f80
  v_mov_b32 v102, 0x3f803f80
  v_mov_b32 v103, 0x3f803f80
  s_mov_b32 s64, 0x100000
f_st9:
  ds_read_b32 v248, v246 offset:16
  s_sub_u32 s64, s64, 1
  s_waitcnt lgkmcnt(0)
  v_cmp_gt_u32 vcc, 10, v248
  s_cmp_eq_u32 s64, 0
  s_cbranch_scc1 f_st9x
  s_cbranch_vccnz f_st9
f_st9x:
  ds_write_b128 v16, v[80:83] offset:10752
  ds_write_b128 v16, v[84:87] offset:12160
  ds_write_b128 v16, v[88:91] offset:13568
  ds_write_b128 v16, v[92:95] offset:14976
  ds_write_b128 v17, v[96:99] offset:11008
  ds_write_b128 v18, v[100:103] offset:11072
  v_mov_b32 v249, 11
  ds_write_b32 v247, v249
  v_mul_u32_u24 v15, 1280, v11
  v_add_u32 v15, s43, v15
  v_lshl_add_u32 v16, v14, 4, v15
  v_lshl_add_u32 v17, v14, 3, v15
  v_pk_mul_f32 v[66:67], v[152:153], v[152:153]
  v_pk_fma_f32 v[66:67], v[154:155], v[154:155], v[66:67]
  v_pk_fma_f32 v[66:67], v[160:161], v[160:161], v[66:67]
  v_pk_fma_f32 v[66:67], v[162:163], v[162:163], v[66:67]
  v_pk_fma_f32 v[66:67], v[168:169], v[168:169], v[66:67]
  v_pk_fma_f32 v[66:67], v[170:171], v[170:171], v[66:67]
  v_pk_fma_f32 v[66:67], v[176:177], v[176:177], v[66:67]
  v_pk_fma_f32 v[66:67], v[178:179], v[178:179], v[66:67]
  v_pk_fma_f32 v[66:67], v[184:185], v[184:185], v[66:67]
  v_pk_fma_f32 v[66:67], v[186:187], v[186:187], v[66:67]
  v_add_f32 v66, v66, v67
  v_cvt_pk_bf16_f32 v56, v152, v153
  v_cvt_pk_bf16_f32 v57, v154, v155
  v_cvt_pk_bf16_f32 v58, v160, v161
  v_cvt_pk_bf16_f32 v59, v162, v163
  v_cvt_pk_bf16_f32 v60, v168, v169
  v_cvt_pk_bf16_f32 v61, v170, v171
  v_cvt_pk_bf16_f32 v62, v176, v177
  v_cvt_pk_bf16_f32 v63, v178, v179
  v_cvt_pk_bf16_f32 v64, v184, v185
  v_cvt_pk_bf16_f32 v65, v186, v187
  ds_write_b128 v16, v[56:59] offset:0
  ds_write_b128 v16, v[60:63] offset:512
  ds_write_b64 v17, v[64:65] offset:1024
  v_pk_mul_f32 v[78:79], v[156:157], v[156:157]
  v_pk_fma_f32 v[78:79], v[158:159], v[158:159], v[78:79]
  v_pk_fma_f32 v[78:79], v[164:165], v[164:165], v[78:79]
  v_pk_fma_f32 v[78:79], v[166:167], v[166:167], v[78:79]
  v_pk_fma_f32 v[78:79], v[172:173], v[172:173], v[78:79]
  v_pk_fma_f32 v[78:79], v[174:175], v[174:175], v[78:79]
  v_pk_fma_f32 v[78:79], v[180:181], v[180:181], v[78:79]
  v_pk_fma_f32 v[78:79], v[182:183], v[182:183], v[78:79]
  v_pk_fma_f32 v[78:79], v[188:189], v[188:189], v[78:79]
  v_pk_fma_f32 v[78:79], v[190:191], v[190:191], v[78:79]
  v_add_f32 v78, v78, v79
  v_cvt_pk_bf16_f32 v68, v156, v157
  v_cvt_pk_bf16_f32 v69, v158, v159
  v_cvt_pk_bf16_f32 v70, v164, v165
  v_cvt_pk_bf16_f32 v71, v166, v167
  v_cvt_pk_bf16_f32 v72, v172, v173
  v_cvt_pk_bf16_f32 v73, v174, v175
  v_cvt_pk_bf16_f32 v74, v180, v181
  v_cvt_pk_bf16_f32 v75, v182, v183
  v_cvt_pk_bf16_f32 v76, v188, v189
  v_cvt_pk_bf16_f32 v77, v190, v191
  ds_write_b128 v16, v[68:71] offset:64
  ds_write_b128 v16, v[72:75] offset:576
  ds_write_b64 v17, v[76:77] offset:1056
  v_max_f32 v18, v66, v78
  v_mul_u32_u24 v15, 1408, v11
  v_add_u32 v15, s43, v15
  v_max_f32_dpp v18, v18, v18 row_ror:8 row_mask:0xf bank_mask:0xf
  s_nop 1
  v_max_f32_dpp v18, v18, v18 row_ror:4 row_mask:0xf bank_mask:0xf
  s_nop 1
  v_max_f32_dpp v18, v18, v18 row_ror:2 row_mask:0xf bank_mask:0xf
  s_nop 1
  v_max_f32_dpp v18, v18, v18 row_ror:1 row_mask:0xf bank_mask:0xf
  v_mov_b32 v248, 12
  ds_write_b32 v15, v18 offset:12156
  ds_write_b32 v247, v248
  s_mov_b32 s46, 1051011932
  s_mov_b32 s47, s46
  v_pk_mul_f32 v[112:113], v[112:113], s[46:47]
  v_pk_mul_f32 v[114:115], v[114:115], s[46:47]
  v_pk_mul_f32 v[116:117], v[116:117], s[46:47]
  v_pk_mul_f32 v[118:119], v[118:119], s[46:47]
  v_pk_mul_f32 v[120:121], v[120:121], s[46:47]
  v_pk_mul_f32 v[122:123], v[122:123], s[46:47]
  v_pk_mul_f32 v[124:125], v[124:125], s[46:47]
  v_pk_mul_f32 v[126:127], v[126:127], s[46:47]
  v_pk_mul_f32 v[128:129], v[128:129], s[46:47]
  v_pk_mul_f32 v[130:131], v[130:131], s[46:47]
  v_pk_mul_f32 v[132:133], v[132:133], s[46:47]
  v_pk_mul_f32 v[134:135], v[134:135], s[46:47]
  v_pk_mul_f32 v[136:137], v[136:137], s[46:47]
  v_pk_mul_f32 v[138:139], v[138:139], s[46:47]
  v_pk_mul_f32 v[140:141], v[140:141], s[46:47]
  v_pk_mul_f32 v[142:143], v[142:143], s[46:47]
  v_pk_mul_f32 v[144:145], v[144:145], s[46:47]
  v_pk_mul_f32 v[146:147], v[146:147], s[46:47]
  v_pk_mul_f32 v[148:149], v[148:149], s[46:47]
  v_pk_mul_f32 v[150:151], v[150:151], s[46:47]
  s_branch f_qo
f_gb:
  ds_read_b64_tr_b16 v[72:73], v52 offset:0
  ds_read_b64_tr_b16 v[74:75], v52 offset:7680
  ds_read_b64_tr_b16 v[76:77], v52 offset:8
  ds_read_b64_tr_b16 v[78:79], v52 offset:7688
  ds_read_b128 v[56:59], v50 offset:32768
  ds_read_b128 v[60:63], v50 offset:33280
  ds_read_b64_tr_b16 v[80:81], v52 offset:16
  ds_read_b64_tr_b16 v[82:83], v52 offset:7696
  ds_read_b64_tr_b16 v[84:85], v52 offset:24
  ds_read_b64_tr_b16 v[86:87], v52 offset:7704
  ds_read_b64_tr_b16 v[88:89], v52 offset:32
  ds_read_b64_tr_b16 v[90:91], v52 offset:7712
  ds_read_b64_tr_b16 v[92:93], v53 offset:160
  ds_read_b64_tr_b16 v[94:95], v53 offset:7840
  ds_read_b64_tr_b16 v[96:97], v53 offset:200
  ds_read_b64_tr_b16 v[98:99], v53 offset:7880
.p2align 6
f_gb_loop:
  s_waitcnt lgkmcnt(10)
  v_mfma_f32_16x16x32_bf16 v[112:115], v[72:75], v[56:59], v[112:115]
  ds_read_b64_tr_b16 v[100:101], v53 offset:240
  v_mfma_f32_16x16x32_bf16 v[116:119], v[72:75], v[60:63], v[116:119]
  ds_read_b64_tr_b16 v[102:103], v53 offset:7920
  v_mfma_f32_16x16x32_bf16 v[120:123], v[76:79], v[56:59], v[120:123]
  ds_read_b64_tr_b16 v[104:105], v53 offset:280
  v_mfma_f32_16x16x32_bf16 v[124:127], v[76:79], v[60:63], v[124:127]
  ds_read_b64_tr_b16 v[106:107], v53 offset:7960
  s_waitcnt lgkmcnt(10)
  v_mfma_f32_16x16x32_bf16 v[128:131], v[80:83], v[56:59], v[128:131]
  ds_read_b64_tr_b16 v[108:109], v52 offset:192
  v_mfma_f32_16x16x32_bf16 v[132:135], v[80:83], v[60:63], v[132:135]
  ds_read_b64_tr_b16 v[110:111], v52 offset:7872
  v_mfma_f32_16x16x32_bf16 v[136:139], v[84:87], v[56:59], v[136:139]
  ds_read_b64_tr_b16 v[72:73], v53 offset:320
  v_mfma_f32_16x16x32_bf16 v[140:143], v[84:87], v[60:63], v[140:143]
  ds_read_b64_tr_b16 v[74:75], v53 offset:8000
  s_waitcnt lgkmcnt(10)
  v_mfma_f32_16x16x32_bf16 v[144:147], v[88:91], v[56:59], v[144:147]
  ds_read_b64_tr_b16 v[76:77], v53 offset:360
  ds_read_b128 v[64:67], v51 offset:32768
  v_mfma_f32_16x16x32_bf16 v[148:151], v[88:91], v[60:63], v[148:151]
  ds_read_b64_tr_b16 v[78:79], v53 offset:8040
  v_mfma_f32_16x16x32_bf16 v[152:155], v[56:59], v[92:95], v[152:155]
  ds_read_b64_tr_b16 v[80:81], v53 offset:400
  ds_read_b128 v[68:71], v51 offset:33280
  v_mfma_f32_16x16x32_bf16 v[156:159], v[60:63], v[92:95], v[156:159]
  ds_read_b64_tr_b16 v[82:83], v53 offset:8080
  s_waitcnt lgkmcnt(12)
  v_mfma_f32_16x16x32_bf16 v[160:163], v[56:59], v[96:99], v[160:163]
  ds_read_b64_tr_b16 v[84:85], v53 offset:440
  v_mfma_f32_16x16x32_bf16 v[164:167], v[60:63], v[96:99], v[164:167]
  ds_read_b64_tr_b16 v[86:87], v53 offset:8120
  v_mfma_f32_16x16x32_bf16 v[168:171], v[56:59], v[100:103], v[168:171]
  ds_read_b64_tr_b16 v[88:89], v52 offset:352
  v_mfma_f32_16x16x32_bf16 v[172:175], v[60:63], v[100:103], v[172:175]
  ds_read_b64_tr_b16 v[90:91], v52 offset:8032
  s_waitcnt lgkmcnt(12)
  v_mfma_f32_16x16x32_bf16 v[176:179], v[56:59], v[104:107], v[176:179]
  ds_read_b64_tr_b16 v[92:93], v52 offset:15360
  v_mfma_f32_16x16x32_bf16 v[180:183], v[60:63], v[104:107], v[180:183]
  ds_read_b64_tr_b16 v[94:95], v52 offset:23040
  v_mfma_f32_16x16x32_bf16 v[184:187], v[56:59], v[108:111], v[184:187]
  ds_read_b64_tr_b16 v[96:97], v52 offset:15368
  v_mfma_f32_16x16x32_bf16 v[188:191], v[60:63], v[108:111], v[188:191]
  ds_read_b64_tr_b16 v[98:99], v52 offset:23048
  s_waitcnt lgkmcnt(11)
  v_mfma_f32_16x16x32_bf16 v[192:195], v[56:59], v[72:75], v[192:195]
  ds_read_b64_tr_b16 v[100:101], v52 offset:15376
  v_mfma_f32_16x16x32_bf16 v[196:199], v[60:63], v[72:75], v[196:199]
  ds_read_b64_tr_b16 v[102:103], v52 offset:23056
  v_mfma_f32_16x16x32_bf16 v[200:203], v[56:59], v[76:79], v[200:203]
  ds_read_b64_tr_b16 v[104:105], v52 offset:15384
  v_mfma_f32_16x16x32_bf16 v[204:207], v[60:63], v[76:79], v[204:207]
  ds_read_b64_tr_b16 v[106:107], v52 offset:23064
  s_waitcnt lgkmcnt(10)
  v_mfma_f32_16x16x32_bf16 v[208:211], v[56:59], v[80:83], v[208:211]
  ds_read_b64_tr_b16 v[108:109], v52 offset:15392
  v_mfma_f32_16x16x32_bf16 v[212:215], v[60:63], v[80:83], v[212:215]
  ds_read_b64_tr_b16 v[110:111], v52 offset:23072
  v_mfma_f32_16x16x32_bf16 v[216:219], v[56:59], v[84:87], v[216:219]
  ds_read_b64_tr_b16 v[72:73], v53 offset:15520
  v_mfma_f32_16x16x32_bf16 v[220:223], v[60:63], v[84:87], v[220:223]
  ds_read_b64_tr_b16 v[74:75], v53 offset:23200
  s_waitcnt lgkmcnt(10)
  v_mfma_f32_16x16x32_bf16 v[224:227], v[56:59], v[88:91], v[224:227]
  ds_read_b64_tr_b16 v[76:77], v53 offset:15560
  v_mfma_f32_16x16x32_bf16 v[228:231], v[60:63], v[88:91], v[228:231]
  ds_read_b64_tr_b16 v[78:79], v53 offset:23240
  v_mfma_f32_16x16x32_bf16 v[112:115], v[92:95], v[64:67], v[112:115]
  ds_read_b64_tr_b16 v[80:81], v53 offset:15600
  v_mfma_f32_16x16x32_bf16 v[116:119], v[92:95], v[68:71], v[116:119]
  ds_read_b64_tr_b16 v[82:83], v53 offset:23280
  s_waitcnt lgkmcnt(10)
  v_mfma_f32_16x16x32_bf16 v[120:123], v[96:99], v[64:67], v[120:123]
  ds_read_b64_tr_b16 v[84:85], v53 offset:15640
  s_add_u32 s45, s45, 1
  v_mfma_f32_16x16x32_bf16 v[124:127], v[96:99], v[68:71], v[124:127]
  ds_read_b64_tr_b16 v[86:87], v53 offset:23320
  s_add_u32 s40, s40, 49152
  v_mfma_f32_16x16x32_bf16 v[128:131], v[100:103], v[64:67], v[128:131]
  ds_read_b64_tr_b16 v[88:89], v52 offset:15552
  s_cmp_eq_u32 s40, 147456
  v_mfma_f32_16x16x32_bf16 v[132:135], v[100:103], v[68:71], v[132:135]
  ds_read_b64_tr_b16 v[90:91], v52 offset:23232
  s_cselect_b32 s41, s42, s43
  s_waitcnt lgkmcnt(10)
  v_mfma_f32_16x16x32_bf16 v[136:139], v[104:107], v[64:67], v[136:139]
  ds_read_b64_tr_b16 v[92:93], v53 offset:15680
  s_cselect_b32 s40, 0, s40
  v_mfma_f32_16x16x32_bf16 v[140:143], v[104:107], v[68:71], v[140:143]
  ds_read_b64_tr_b16 v[94:95], v53 offset:23360
  v_mfma_f32_16x16x32_bf16 v[144:147], v[108:111], v[64:67], v[144:147]
  ds_read_b64_tr_b16 v[96:97], v53 offset:15720
  v_mfma_f32_16x16x32_bf16 v[148:151], v[108:111], v[68:71], v[148:151]
  ds_read_b64_tr_b16 v[98:99], v53 offset:23400
  s_waitcnt lgkmcnt(10)
  v_mfma_f32_16x16x32_bf16 v[152:155], v[64:67], v[72:75], v[152:155]
  ds_read_b32 v248, v246
  ds_read_b64_tr_b16 v[100:101], v53 offset:15760
  v_mfma_f32_16x16x32_bf16 v[156:159], v[68:71], v[72:75], v[156:159]
  ds_read_b64_tr_b16 v[102:103], v53 offset:23440
  v_mfma_f32_16x16x32_bf16 v[160:163], v[64:67], v[76:79], v[160:163]
  ds_read_b64_tr_b16 v[104:105], v53 offset:15800
  v_mfma_f32_16x16x32_bf16 v[164:167], v[68:71], v[76:79], v[164:167]
  ds_read_b64_tr_b16 v[106:107], v53 offset:23480
  s_waitcnt lgkmcnt(11)
  v_mfma_f32_16x16x32_bf16 v[168:171], v[64:67], v[80:83], v[168:171]
  ds_read_b64_tr_b16 v[108:109], v52 offset:15712
  v_mfma_f32_16x16x32_bf16 v[172:175], v[68:71], v[80:83], v[172:175]
  ds_read_b64_tr_b16 v[110:111], v52 offset:23392
  v_mfma_f32_16x16x32_bf16 v[176:179], v[64:67], v[84:87], v[176:179]
  v_add_u32 v50, s41, v50
  v_add_u32 v52, s41, v52
  v_mfma_f32_16x16x32_bf16 v[180:183], v[68:71], v[84:87], v[180:183]
  v_add_u32 v51, s41, v51
  v_add_u32 v53, s41, v53
  s_waitcnt lgkmcnt(9)
  v_mfma_f32_16x16x32_bf16 v[184:187], v[64:67], v[88:91], v[184:187]
  s_waitcnt lgkmcnt(6)
  v_cmp_ge_u32 vcc, s45, v248
  v_mfma_f32_16x16x32_bf16 v[188:191], v[68:71], v[88:91], v[188:191]
  v_mov_b32 v249, s45
  s_cbranch_vccz f_gb_ok
  s_mov_b32 s64, 0x100000
f_gb_s:
  ds_read_b32 v248, v246 offset:0
  s_sub_u32 s64, s64, 1
  s_waitcnt lgkmcnt(0)
  v_cmp_ge_u32 vcc, s45, v248
  s_cmp_eq_u32 s64, 0
  s_cbranch_scc1 f_gb_sx
  s_cbranch_vccnz f_gb_s
f_gb_sx:
f_gb_ok:
  v_mfma_f32_16x16x32_bf16 v[192:195], v[64:67], v[92:95], v[192:195]
  ds_read_b64_tr_b16 v[72:73], v52 offset:0
  ds_read_b64_tr_b16 v[74:75], v52 offset:7680
  v_mfma_f32_16x16x32_bf16 v[196:199], v[68:71], v[92:95], v[196:199]
  ds_read_b64_tr_b16 v[76:77], v52 offset:8
  ds_read_b64_tr_b16 v[78:79], v52 offset:7688
  s_waitcnt lgkmcnt(8)
  v_mfma_f32_16x16x32_bf16 v[200:203], v[64:67], v[96:99], v[200:203]
  ds_read_b128 v[56:59], v50 offset:32768
  ds_read_b128 v[60:63], v50 offset:33280
  v_mfma_f32_16x16x32_bf16 v[204:207], v[68:71], v[96:99], v[204:207]
  ds_read_b64_tr_b16 v[80:81], v52 offset:16
  ds_read_b64_tr_b16 v[82:83], v52 offset:7696
  v_mfma_f32_16x16x32_bf16 v[208:211], v[64:67], v[100:103], v[208:211]
  ds_read_b64_tr_b16 v[84:85], v52 offset:24
  ds_read_b64_tr_b16 v[86:87], v52 offset:7704
  v_mfma_f32_16x16x32_bf16 v[212:215], v[68:71], v[100:103], v[212:215]
  ds_read_b64_tr_b16 v[88:89], v52 offset:32
  ds_read_b64_tr_b16 v[90:91], v52 offset:7712
  s_waitcnt lgkmcnt(12)
  v_mfma_f32_16x16x32_bf16 v[216:219], v[64:67], v[104:107], v[216:219]
  ds_read_b64_tr_b16 v[92:93], v53 offset:160
  ds_write_b32 v247, v249
  v_mfma_f32_16x16x32_bf16 v[220:223], v[68:71], v[104:107], v[220:223]
  ds_read_b64_tr_b16 v[94:95], v53 offset:7840
  v_mfma_f32_16x16x32_bf16 v[224:227], v[64:67], v[108:111], v[224:227]
  ds_read_b64_tr_b16 v[96:97], v53 offset:200
  v_mfma_f32_16x16x32_bf16 v[228:231], v[68:71], v[108:111], v[228:231]
  ds_read_b64_tr_b16 v[98:99], v53 offset:7880
  s_cmp_lt_u32 s45, 10
  s_cbranch_scc1 f_gb_loop
  s_waitcnt lgkmcnt(0)
  ds_read_b32 v20, v49 offset:36
  v_and_b32 v10, 15, v1
  v_lshrrev_b32 v11, 4, v1
  v_lshrrev_b32 v12, 2, v10
  v_and_b32 v13, 3, v10
  v_lshl_add_u32 v14, v12, 3, v13
  s_lshl_b32 s43, s57, 14
  s_add_u32 s43, s43, 98304
  v_cvt_pk_bf16_f32 v76, v192, v193
  v_cvt_pk_bf16_f32 v77, v194, v195
  v_cvt_pk_bf16_f32 v78, v196, v197
  v_cvt_pk_bf16_f32 v79, v198, v199
  v_cvt_pk_bf16_f32 v80, v200, v201
  v_cvt_pk_bf16_f32 v81, v202, v203
  v_cvt_pk_bf16_f32 v82, v204, v205
  v_cvt_pk_bf16_f32 v83, v206, v207
  v_cvt_pk_bf16_f32 v84, v208, v209
  v_cvt_pk_bf16_f32 v85, v210, v211
  v_cvt_pk_bf16_f32 v86, v212, v213
  v_cvt_pk_bf16_f32 v87, v214, v215
  v_cvt_pk_bf16_f32 v88, v216, v217
  v_cvt_pk_bf16_f32 v89, v218, v219
  v_cvt_pk_bf16_f32 v90, v220, v221
  v_cvt_pk_bf16_f32 v91, v222, v223
  v_cvt_pk_bf16_f32 v92, v224, v225
  v_cvt_pk_bf16_f32 v93, v226, v227
  v_cvt_pk_bf16_f32 v94, v228, v229
  v_cvt_pk_bf16_f32 v95, v230, v231
  v_pk_mul_f32 v[192:193], v[152:153], s[60:61]
  v_pk_mul_f32 v[194:195], v[154:155], s[60:61]
  v_pk_mul_f32 v[196:197], v[156:157], s[60:61]
  v_pk_mul_f32 v[198:199], v[158:159], s[60:61]
  v_pk_mul_f32 v[200:201], v[160:161], s[60:61]
  v_pk_mul_f32 v[202:203], v[162:163], s[60:61]
  v_pk_mul_f32 v[204:205], v[164:165], s[60:61]
  v_pk_mul_f32 v[206:207], v[166:167], s[60:61]
  v_pk_mul_f32 v[208:209], v[168:169], s[60:61]
  v_pk_mul_f32 v[210:211], v[170:171], s[60:61]
  v_pk_mul_f32 v[212:213], v[172:173], s[60:61]
  v_pk_mul_f32 v[214:215], v[174:175], s[60:61]
  v_pk_mul_f32 v[216:217], v[176:177], s[60:61]
  v_pk_mul_f32 v[218:219], v[178:179], s[60:61]
  v_pk_mul_f32 v[220:221], v[180:181], s[60:61]
  v_pk_mul_f32 v[222:223], v[182:183], s[60:61]
  v_pk_mul_f32 v[224:225], v[184:185], s[60:61]
  v_pk_mul_f32 v[226:227], v[186:187], s[60:61]
  v_pk_mul_f32 v[228:229], v[188:189], s[60:61]
  v_pk_mul_f32 v[230:231], v[190:191], s[60:61]
  v_exp_f32_e64 v192, v192 clamp
  v_exp_f32_e64 v193, v193 clamp
  v_exp_f32_e64 v194, v194 clamp
  v_exp_f32_e64 v195, v195 clamp
  v_exp_f32_e64 v196, v196 clamp
  v_exp_f32_e64 v197, v197 clamp
  v_exp_f32_e64 v198, v198 clamp
  v_exp_f32_e64 v199, v199 clamp
  v_exp_f32_e64 v200, v200 clamp
  v_exp_f32_e64 v201, v201 clamp
  v_exp_f32_e64 v202, v202 clamp
  v_exp_f32_e64 v203, v203 clamp
  v_exp_f32_e64 v204, v204 clamp
  v_exp_f32_e64 v205, v205 clamp
  v_exp_f32_e64 v206, v206 clamp
  v_exp_f32_e64 v207, v207 clamp
  v_exp_f32_e64 v208, v208 clamp
  v_exp_f32_e64 v209, v209 clamp
  v_exp_f32_e64 v210, v210 clamp
  v_exp_f32_e64 v211, v211 clamp
  v_exp_f32_e64 v212, v212 clamp
  v_exp_f32_e64 v213, v213 clamp
  v_exp_f32_e64 v214, v214 clamp
  v_exp_f32_e64 v215, v215 clamp
  v_exp_f32_e64 v216, v216 clamp
  v_exp_f32_e64 v217, v217 clamp
  v_exp_f32_e64 v218, v218 clamp
  v_exp_f32_e64 v219, v219 clamp
  v_exp_f32_e64 v220, v220 clamp
  v_exp_f32_e64 v221, v221 clamp
  v_exp_f32_e64 v222, v222 clamp
  v_exp_f32_e64 v223, v223 clamp
  v_exp_f32_e64 v224, v224 clamp
  v_exp_f32_e64 v225, v225 clamp
  v_exp_f32_e64 v226, v226 clamp
  v_exp_f32_e64 v227, v227 clamp
  v_exp_f32_e64 v228, v228 clamp
  v_exp_f32_e64 v229, v229 clamp
  v_exp_f32_e64 v230, v230 clamp
  v_exp_f32_e64 v231, v231 clamp
  v_max_f32 v152, 0, v152
  v_max_f32 v153, 0, v153
  v_max_f32 v154, 0, v154
  v_max_f32 v155, 0, v155
  v_max_f32 v156, 0, v156
  v_max_f32 v157, 0, v157
  v_max_f32 v158, 0, v158
  v_max_f32 v159, 0, v159
  v_max_f32 v160, 0, v160
  v_max_f32 v161, 0, v161
  v_max_f32 v162, 0, v162
  v_max_f32 v163, 0, v163
  v_max_f32 v164, 0, v164
  v_max_f32 v165, 0, v165
  v_max_f32 v166, 0, v166
  v_max_f32 v167, 0, v167
  v_max_f32 v168, 0, v168
  v_max_f32 v169, 0, v169
  v_max_f32 v170, 0, v170
  v_max_f32 v171, 0, v171
  v_max_f32 v172, 0, v172
  v_max_f32 v173, 0, v173
  v_max_f32 v174, 0, v174
  v_max_f32 v175, 0, v175
  v_max_f32 v176, 0, v176
  v_max_f32 v177, 0, v177
  v_max_f32 v178, 0, v178
  v_max_f32 v179, 0, v179
  v_max_f32 v180, 0, v180
  v_max_f32 v181, 0, v181
  v_max_f32 v182, 0, v182
  v_max_f32 v183, 0, v183
  v_max_f32 v184, 0, v184
  v_max_f32 v185, 0, v185
  v_max_f32 v186, 0, v186
  v_max_f32 v187, 0, v187
  v_max_f32 v188, 0, v188
  v_max_f32 v189, 0, v189
  v_max_f32 v190, 0, v190
  v_max_f32 v191, 0, v191
  v_pk_add_f32 v[192:193], v[192:193], s[96:97]
  v_pk_add_f32 v[194:195], v[194:195], s[96:97]
  v_pk_add_f32 v[196:197], v[196:197], s[96:97]
  v_pk_add_f32 v[198:199], v[198:199], s[96:97]
  v_pk_add_f32 v[200:201], v[200:201], s[96:97]
  v_pk_add_f32 v[202:203], v[202:203], s[96:97]
  v_pk_add_f32 v[204:205], v[204:205], s[96:97]
  v_pk_add_f32 v[206:207], v[206:207], s[96:97]
  v_pk_add_f32 v[208:209], v[208:209], s[96:97]
  v_pk_add_f32 v[210:211], v[210:211], s[96:97]
  v_pk_add_f32 v[212:213], v[212:213], s[96:97]
  v_pk_add_f32 v[214:215], v[214:215], s[96:97]
  v_pk_add_f32 v[216:217], v[216:217], s[96:97]
  v_pk_add_f32 v[218:219], v[218:219], s[96:97]
  v_pk_add_f32 v[220:221], v[220:221], s[96:97]
  v_pk_add_f32 v[222:223], v[222:223], s[96:97]
  v_pk_add_f32 v[224:225], v[224:225], s[96:97]
  v_pk_add_f32 v[226:227], v[226:227], s[96:97]
  v_pk_add_f32 v[228:229], v[228:229], s[96:97]
  v_pk_add_f32 v[230:231], v[230:231], s[96:97]
  v_pk_add_f32 v[152:153], v[152:153], v[192:193]
  v_pk_add_f32 v[154:155], v[154:155], v[194:195]
  v_pk_add_f32 v[156:157], v[156:157], v[196:197]
  v_pk_add_f32 v[158:159], v[158:159], v[198:199]
  v_pk_add_f32 v[160:161], v[160:161], v[200:201]
  v_pk_add_f32 v[162:163], v[162:163], v[202:203]
  v_pk_add_f32 v[164:165], v[164:165], v[204:205]
  v_pk_add_f32 v[166:167], v[166:167], v[206:207]
  v_pk_add_f32 v[168:169], v[168:169], v[208:209]
  v_pk_add_f32 v[170:171], v[170:171], v[210:211]
  v_pk_add_f32 v[172:173], v[172:173], v[212:213]
  v_pk_add_f32 v[174:175], v[174:175], v[214:215]
  v_pk_add_f32 v[176:177], v[176:177], v[216:217]
  v_pk_add_f32 v[178:179], v[178:179], v[218:219]
  v_pk_add_f32 v[180:181], v[180:181], v[220:221]
  v_pk_add_f32 v[182:183], v[182:183], v[222:223]
  v_pk_add_f32 v[184:185], v[184:185], v[224:225]
  v_pk_add_f32 v[186:187], v[186:187], v[226:227]
  v_pk_add_f32 v[188:189], v[188:189], v[228:229]
  v_pk_add_f32 v[190:191], v[190:191], v[230:231]
  v_cvt_pk_bf16_f32 v56, v152, v153
  v_cvt_pk_bf16_f32 v57, v154, v155
  v_cvt_pk_bf16_f32 v58, v156, v157
  v_cvt_pk_bf16_f32 v59, v158, v159
  v_cvt_pk_bf16_f32 v60, v160, v161
  v_cvt_pk_bf16_f32 v61, v162, v163
  v_cvt_pk_bf16_f32 v62, v164, v165
  v_cvt_pk_bf16_f32 v63, v166, v167
  v_cvt_pk_bf16_f32 v64, v168, v169
  v_cvt_pk_bf16_f32 v65, v170, v171
  v_cvt_pk_bf16_f32 v66, v172, v173
  v_cvt_pk_bf16_f32 v67, v174, v175
  v_cvt_pk_bf16_f32 v68, v176, v177
  v_cvt_pk_bf16_f32 v69, v178, v179
  v_cvt_pk_bf16_f32 v70, v180, v181
  v_cvt_pk_bf16_f32 v71, v182, v183
  v_cvt_pk_bf16_f32 v72, v184, v185
  v_cvt_pk_bf16_f32 v73, v186, v187
  v_cvt_pk_bf16_f32 v74, v188, v189
  v_cvt_pk_bf16_f32 v75, v190, v191
  v_mov_b32 v96, 0x3f803f80
  v_mov_b32 v97, 0x3f803f80
  v_mov_b32 v98, 0x3f803f80
  v_mov_b32 v99, 0x3f803f80
  v_mul_u32_u24 v17, 80, v10
  v_lshl_add_u32 v17, v11, 4, v17
  v_add_u32 v17, s43, v17
  v_mul_u32_u24 v18, 80, v13
  v_mul_u32_u24 v19, 1680, v11
  v_add3_u32 v19, v19, v18, s43
  v_cmp_eq_u32 vcc, 3, v11
  v_add_u32 v15, 5712, v19
  s_nop 0
  v_cndmask_b32 v19, v19, v15, vcc
  v_lshl_add_u32 v18, v11, 4, v18
  v_add_u32 v18, s43, v18
  v_mfma_f32_16x16x32_bf16 v[152:155], v[56:59], v[76:79], 0
  v_mfma_f32_16x16x32_bf16 v[156:159], v[60:63], v[80:83], 0
  v_mfma_f32_16x16x32_bf16 v[160:163], v[64:67], v[84:87], 0
  v_mfma_f32_16x16x32_bf16 v[164:167], v[68:71], v[88:91], 0
  v_mfma_f32_16x16x32_bf16 v[168:171], v[56:59], v[92:95], 0
  v_mfma_f32_16x16x32_bf16 v[172:175], v[60:63], v[92:95], 0
  v_mfma_f32_16x16x32_bf16 v[176:179], v[64:67], v[92:95], 0
  v_mfma_f32_16x16x32_bf16 v[180:183], v[68:71], v[92:95], 0
  v_mfma_f32_16x16x32_bf16 v[184:187], v[72:75], v[76:79], 0
  v_mfma_f32_16x16x32_bf16 v[188:191], v[72:75], v[80:83], 0
  v_mfma_f32_16x16x32_bf16 v[192:195], v[72:75], v[84:87], 0
  v_mfma_f32_16x16x32_bf16 v[196:199], v[72:75], v[88:91], 0
  v_mfma_f32_16x16x32_bf16 v[200:203], v[72:75], v[92:95], 0
  v_mfma_f32_16x16x32_bf16 v[204:207], v[56:59], v[96:99], 0
  v_mfma_f32_16x16x32_bf16 v[208:211], v[60:63], v[96:99], 0
  v_mfma_f32_16x16x32_bf16 v[212:215], v[64:67], v[96:99], 0
  v_mfma_f32_16x16x32_bf16 v[216:219], v[68:71], v[96:99], 0
  v_mfma_f32_16x16x32_bf16 v[220:223], v[72:75], v[96:99], 0
  s_mov_b32 s64, 0x100000
f_st9b:
  ds_read_b32 v248, v246 offset:16
  s_sub_u32 s64, s64, 1
  s_waitcnt lgkmcnt(0)
  v_cmp_gt_u32 vcc, 10, v248
  s_cmp_eq_u32 s64, 0
  s_cbranch_scc1 f_st9bx
  s_cbranch_vccnz f_st9b
f_st9bx:
  ds_write_b128 v17, v[152:155] offset:0
  ds_write_b128 v17, v[156:159] offset:1680
  ds_write_b128 v17, v[160:163] offset:3360
  ds_write_b128 v17, v[164:167] offset:10752
  s_mov_b32 exec_lo, 983055
  s_mov_b32 exec_hi, 983055
  ds_write_b128 v18, v[168:171] offset:1280
  s_mov_b32 exec_lo, 15728880
  s_mov_b32 exec_hi, 15728880
  ds_write_b128 v18, v[172:175] offset:2960
  s_mov_b32 exec_lo, 251662080
  s_mov_b32 exec_hi, 251662080
  ds_write_b128 v18, v[176:179] offset:4640
  s_mov_b32 exec_lo, 4026593280
  s_mov_b32 exec_hi, 4026593280
  ds_write_b128 v18, v[180:183] offset:12032
  s_mov_b32 exec_lo, 65535
  s_mov_b32 exec_hi, 0
  ds_write_b128 v17, v[184:187] offset:64
  s_mov_b32 exec_lo, 4294901760
  ds_write_b128 v17, v[188:191] offset:1728
  s_mov_b32 exec_lo, 0
  s_mov_b32 exec_hi, 65535
  ds_write_b128 v17, v[192:195] offset:3392
  s_mov_b32 exec_hi, 4294901760
  ds_write_b128 v17, v[196:199] offset:10768
  s_mov_b32 exec_lo, 15728655
  s_mov_b32 exec_hi, 4026535680
  ds_write_b128 v19, v[200:203] offset:1344
  s_mov_b32 exec_lo, 65537
  s_mov_b32 exec_hi, 65537
  ds_write_b128 v17, v[204:207] offset:1600
  ds_write_b128 v17, v[208:211] offset:3280
  ds_write_b128 v17, v[212:215] offset:4960
  ds_write_b128 v17, v[216:219] offset:12352
  ds_write_b128 v19, v[220:223] offset:1664
  s_mov_b64 exec, -1
  v_pk_mul_f32 v[56:57], v[112:113], s[60:61]
  v_pk_mul_f32 v[58:59], v[114:115], s[60:61]
  v_pk_mul_f32 v[60:61], v[116:117], s[60:61]
  v_pk_mul_f32 v[62:63], v[118:119], s[60:61]
  v_pk_mul_f32 v[64:65], v[120:121], s[60:61]
  v_pk_mul_f32 v[66:67], v[122:123], s[60:61]
  v_pk_mul_f32 v[68:69], v[124:125], s[60:61]
  v_pk_mul_f32 v[70:71], v[126:127], s[60:61]
  v_pk_mul_f32 v[72:73], v[128:129], s[60:61]
  v_pk_mul_f32 v[74:75], v[130:131], s[60:61]
  v_pk_mul_f32 v[76:77], v[132:133], s[60:61]
  v_pk_mul_f32 v[78:79], v[134:135], s[60:61]
  v_pk_mul_f32 v[80:81], v[136:137], s[60:61]
  v_pk_mul_f32 v[82:83], v[138:139], s[60:61]
  v_pk_mul_f32 v[84:85], v[140:141], s[60:61]
  v_pk_mul_f32 v[86:87], v[142:143], s[60:61]
  v_pk_mul_f32 v[88:89], v[144:145], s[60:61]
  v_pk_mul_f32 v[90:91], v[146:147], s[60:61]
  v_pk_mul_f32 v[92:93], v[148:149], s[60:61]
  v_pk_mul_f32 v[94:95], v[150:151], s[60:61]
  v_exp_f32_e64 v56, v56 clamp
  v_exp_f32_e64 v57, v57 clamp
  v_exp_f32_e64 v58, v58 clamp
  v_exp_f32_e64 v59, v59 clamp
  v_exp_f32_e64 v60, v60 clamp
  v_exp_f32_e64 v61, v61 clamp
  v_exp_f32_e64 v62, v62 clamp
  v_exp_f32_e64 v63, v63 clamp
  v_exp_f32_e64 v64, v64 clamp
  v_exp_f32_e64 v65, v65 clamp
  v_exp_f32_e64 v66, v66 clamp
  v_exp_f32_e64 v67, v67 clamp
  v_exp_f32_e64 v68, v68 clamp
  v_exp_f32_e64 v69, v69 clamp
  v_exp_f32_e64 v70, v70 clamp
  v_exp_f32_e64 v71, v71 clamp
  v_exp_f32_e64 v72, v72 clamp
  v_exp_f32_e64 v73, v73 clamp
  v_exp_f32_e64 v74, v74 clamp
  v_exp_f32_e64 v75, v75 clamp
  v_exp_f32_e64 v76, v76 clamp
  v_exp_f32_e64 v77, v77 clamp
  v_exp_f32_e64 v78, v78 clamp
  v_exp_f32_e64 v79, v79 clamp
  v_exp_f32_e64 v80, v80 clamp
  v_exp_f32_e64 v81, v81 clamp
  v_exp_f32_e64 v82, v82 clamp
  v_exp_f32_e64 v83, v83 clamp
  v_exp_f32_e64 v84, v84 clamp
  v_exp_f32_e64 v85, v85 clamp
  v_exp_f32_e64 v86, v86 clamp
  v_exp_f32_e64 v87, v87 clamp
  v_exp_f32_e64 v88, v88 clamp
  v_exp_f32_e64 v89, v89 clamp
  v_exp_f32_e64 v90, v90 clamp
  v_exp_f32_e64 v91, v91 clamp
  v_exp_f32_e64 v92, v92 clamp
  v_exp_f32_e64 v93, v93 clamp
  v_exp_f32_e64 v94, v94 clamp
  v_exp_f32_e64 v95, v95 clamp
  v_max_f32 v112, 0, v112
  v_max_f32 v113, 0, v113
  v_max_f32 v114, 0, v114
  v_max_f32 v115, 0, v115
  v_max_f32 v116, 0, v116
  v_max_f32 v117, 0, v117
  v_max_f32 v118, 0, v118
  v_max_f32 v119, 0, v119
  v_max_f32 v120, 0, v120
  v_max_f32 v121, 0, v121
  v_max_f32 v122, 0, v122
  v_max_f32 v123, 0, v123
  v_max_f32 v124, 0, v124
  v_max_f32 v125, 0, v125
  v_max_f32 v126, 0, v126
  v_max_f32 v127, 0, v127
  v_max_f32 v128, 0, v128
  v_max_f32 v129, 0, v129
  v_max_f32 v130, 0, v130
  v_max_f32 v131, 0, v131
  v_max_f32 v132, 0, v132
  v_max_f32 v133, 0, v133
  v_max_f32 v134, 0, v134
  v_max_f32 v135, 0, v135
  v_max_f32 v136, 0, v136
  v_max_f32 v137, 0, v137
  v_max_f32 v138, 0, v138
  v_max_f32 v139, 0, v139
  v_max_f32 v140, 0, v140
  v_max_f32 v141, 0, v141
  v_max_f32 v142, 0, v142
  v_max_f32 v143, 0, v143
  v_max_f32 v144, 0, v144
  v_max_f32 v145, 0, v145
  v_max_f32 v146, 0, v146
  v_max_f32 v147, 0, v147
  v_max_f32 v148, 0, v148
  v_max_f32 v149, 0, v149
  v_max_f32 v150, 0, v150
  v_max_f32 v151, 0, v151
  v_pk_add_f32 v[56:57], v[56:57], s[96:97]
  v_pk_add_f32 v[58:59], v[58:59], s[96:97]
  v_pk_add_f32 v[60:61], v[60:61], s[96:97]
  v_pk_add_f32 v[62:63], v[62:63], s[96:97]
  v_pk_add_f32 v[64:65], v[64:65], s[96:97]
  v_pk_add_f32 v[66:67], v[66:67], s[96:97]
  v_pk_add_f32 v[68:69], v[68:69], s[96:97]
  v_pk_add_f32 v[70:71], v[70:71], s[96:97]
  v_pk_add_f32 v[72:73], v[72:73], s[96:97]
  v_pk_add_f32 v[74:75], v[74:75], s[96:97]
  v_pk_add_f32 v[76:77], v[76:77], s[96:97]
  v_pk_add_f32 v[78:79], v[78:79], s[96:97]
  v_pk_add_f32 v[80:81], v[80:81], s[96:97]
  v_pk_add_f32 v[82:83], v[82:83], s[96:97]
  v_pk_add_f32 v[84:85], v[84:85], s[96:97]
  v_pk_add_f32 v[86:87], v[86:87], s[96:97]
  v_pk_add_f32 v[88:89], v[88:89], s[96:97]
  v_pk_add_f32 v[90:91], v[90:91], s[96:97]
  v_pk_add_f32 v[92:93], v[92:93], s[96:97]
  v_pk_add_f32 v[94:95], v[94:95], s[96:97]
  v_pk_add_f32 v[112:113], v[112:113], v[56:57]
  v_pk_add_f32 v[114:115], v[114:115], v[58:59]
  v_pk_add_f32 v[116:117], v[116:117], v[60:61]
  v_pk_add_f32 v[118:119], v[118:119], v[62:63]
  v_pk_add_f32 v[120:121], v[120:121], v[64:65]
  v_pk_add_f32 v[122:123], v[122:123], v[66:67]
  v_pk_add_f32 v[124:125], v[124:125], v[68:69]
  v_pk_add_f32 v[126:127], v[126:127], v[70:71]
  v_pk_add_f32 v[128:129], v[128:129], v[72:73]
  v_pk_add_f32 v[130:131], v[130:131], v[74:75]
  v_pk_add_f32 v[132:133], v[132:133], v[76:77]
  v_pk_add_f32 v[134:135], v[134:135], v[78:79]
  v_pk_add_f32 v[136:137], v[136:137], v[80:81]
  v_pk_add_f32 v[138:139], v[138:139], v[82:83]
  v_pk_add_f32 v[140:141], v[140:141], v[84:85]
  v_pk_add_f32 v[142:143], v[142:143], v[86:87]
  v_pk_add_f32 v[144:145], v[144:145], v[88:89]
  v_pk_add_f32 v[146:147], v[146:147], v[90:91]
  v_pk_add_f32 v[148:149], v[148:149], v[92:93]
  v_pk_add_f32 v[150:151], v[150:151], v[94:95]
f_qo:
  v_mul_u32_u24 v15, 1408, v11
  v_add_u32 v15, s43, v15
  v_lshl_add_u32 v16, v14, 4, v15
  v_lshl_add_u32 v17, v14, 3, v15
  v_lshl_add_u32 v18, v14, 2, v15
  v_pk_mul_f32 v[66:67], v[112:113], v[112:113]
  v_pk_fma_f32 v[66:67], v[114:115], v[114:115], v[66:67]
  v_pk_fma_f32 v[66:67], v[120:121], v[120:121], v[66:67]
  v_pk_fma_f32 v[66:67], v[122:123], v[122:123], v[66:67]
  v_pk_fma_f32 v[66:67], v[128:129], v[128:129], v[66:67]
  v_pk_fma_f32 v[66:67], v[130:131], v[130:131], v[66:67]
  v_pk_fma_f32 v[66:67], v[136:137], v[136:137], v[66:67]
  v_pk_fma_f32 v[66:67], v[138:139], v[138:139], v[66:67]
  v_pk_fma_f32 v[66:67], v[144:145], v[144:145], v[66:67]
  v_pk_fma_f32 v[66:67], v[146:147], v[146:147], v[66:67]
  v_add_f32 v66, v66, v67
  v_cvt_pk_bf16_f32 v56, v112, v113
  v_cvt_pk_bf16_f32 v57, v114, v115
  v_cvt_pk_bf16_f32 v58, v120, v121
  v_cvt_pk_bf16_f32 v59, v122, v123
  v_cvt_pk_bf16_f32 v60, v128, v129
  v_cvt_pk_bf16_f32 v61, v130, v131
  v_cvt_pk_bf16_f32 v62, v136, v137
  v_cvt_pk_bf16_f32 v63, v138, v139
  v_cvt_pk_bf16_f32 v64, v144, v145
  v_cvt_pk_bf16_f32 v65, v146, v147
  ds_write_b128 v16, v[56:59] offset:5120
  ds_write_b128 v16, v[60:63] offset:5632
  ds_write_b64 v17, v[64:65] offset:6144
  ds_write_b32 v18, v66 offset:6400
  v_pk_mul_f32 v[78:79], v[116:117], v[116:117]
  v_pk_fma_f32 v[78:79], v[118:119], v[118:119], v[78:79]
  v_pk_fma_f32 v[78:79], v[124:125], v[124:125], v[78:79]
  v_pk_fma_f32 v[78:79], v[126:127], v[126:127], v[78:79]
  v_pk_fma_f32 v[78:79], v[132:133], v[132:133], v[78:79]
  v_pk_fma_f32 v[78:79], v[134:135], v[134:135], v[78:79]
  v_pk_fma_f32 v[78:79], v[140:141], v[140:141], v[78:79]
  v_pk_fma_f32 v[78:79], v[142:143], v[142:143], v[78:79]
  v_pk_fma_f32 v[78:79], v[148:149], v[148:149], v[78:79]
  v_pk_fma_f32 v[78:79], v[150:151], v[150:151], v[78:79]
  v_add_f32 v78, v78, v79
  v_cvt_pk_bf16_f32 v68, v116, v117
  v_cvt_pk_bf16_f32 v69, v118, v119
  v_cvt_pk_bf16_f32 v70, v124, v125
  v_cvt_pk_bf16_f32 v71, v126, v127
  v_cvt_pk_bf16_f32 v72, v132, v133
  v_cvt_pk_bf16_f32 v73, v134, v135
  v_cvt_pk_bf16_f32 v74, v140, v141
  v_cvt_pk_bf16_f32 v75, v142, v143
  v_cvt_pk_bf16_f32 v76, v148, v149
  v_cvt_pk_bf16_f32 v77, v150, v151
  ds_write_b128 v16, v[68:71] offset:5184
  ds_write_b128 v16, v[72:75] offset:5696
  ds_write_b64 v17, v[76:77] offset:6176
  ds_write_b32 v18, v78 offset:6416
  v_mov_b32 v249, 13
  ds_write_b32 v247, v249
  v_readfirstlane_b32 s19, v20
  s_mul_i32 s3, s18, 160
  s_mov_b32 s52, 0x199a
  v_add_u32 v10, 0, v1
  v_mul_u32_u24 v11, s52, v10
  v_lshrrev_b32 v11, 16, v11
  v_mul_u32_u24 v12, 10, v11
  v_sub_u32 v12, v10, v12
  v_lshl_add_u32 v12, v12, 4, s3
  v_bfe_u32 v13, v11, 2, 2
  v_lshrrev_b32 v14, 4, v11
  v_and_b32 v15, 3, v11
  v_lshl_add_u32 v15, v14, 2, v15
  v_mul_u32_u24 v16, 80, v13
  v_mul_u32_u24 v17, 36, v14
  v_add3_u32 v16, v16, v15, v17
  v_add_u32 v16, 16, v16
  v_mul_u32_u24 v16, 1280, v16
  v_add_u32 v204, v16, v12
  v_add_u32 v10, 0, v1
  v_mul_u32_u24 v11, s52, v10
  v_lshrrev_b32 v11, 16, v11
  v_mul_u32_u24 v12, 10, v11
  v_sub_u32 v12, v10, v12
  v_lshl_add_u32 v12, v12, 4, s3
  v_bfe_u32 v13, v11, 2, 2
  v_lshrrev_b32 v14, 4, v11
  v_and_b32 v15, 3, v11
  v_lshl_add_u32 v15, v14, 2, v15
  v_lshrrev_b32 v17, 1, v13
  v_mul_u32_u24 v17, 24, v17
  v_lshl_add_u32 v16, v13, 3, v15
  v_add_u32 v16, v16, v17
  v_mul_u32_u24 v16, 1280, v16
  v_add_u32 v209, v16, v12
  v_add_u32 v10, 64, v1
  v_mul_u32_u24 v11, s52, v10
  v_lshrrev_b32 v11, 16, v11
  v_mul_u32_u24 v12, 10, v11
  v_sub_u32 v12, v10, v12
  v_lshl_add_u32 v12, v12, 4, s3
  v_bfe_u32 v13, v11, 2, 2
  v_lshrrev_b32 v14, 4, v11
  v_and_b32 v15, 3, v11
  v_lshl_add_u32 v15, v14, 2, v15
  v_mul_u32_u24 v16, 80, v13
  v_mul_u32_u24 v17, 36, v14
  v_add3_u32 v16, v16, v15, v17
  v_add_u32 v16, 16, v16
  v_mul_u32_u24 v16, 1280, v16
  v_add_u32 v205, v16, v12
  v_add_u32 v10, 64, v1
  v_mul_u32_u24 v11, s52, v10
  v_lshrrev_b32 v11, 16, v11
  v_mul_u32_u24 v12, 10, v11
  v_sub_u32 v12, v10, v12
  v_lshl_add_u32 v12, v12, 4, s3
  v_bfe_u32 v13, v11, 2, 2
  v_lshrrev_b32 v14, 4, v11
  v_and_b32 v15, 3, v11
  v_lshl_add_u32 v15, v14, 2, v15
  v_lshrrev_b32 v17, 1, v13
  v_mul_u32_u24 v17, 24, v17
  v_lshl_add_u32 v16, v13, 3, v15
  v_add_u32 v16, v16, v17
  v_mul_u32_u24 v16, 1280, v16
  v_add_u32 v210, v16, v12
  v_add_u32 v10, 128, v1
  v_mul_u32_u24 v11, s52, v10
  v_lshrrev_b32 v11, 16, v11
  v_mul_u32_u24 v12, 10, v11
  v_sub_u32 v12, v10, v12
  v_lshl_add_u32 v12, v12, 4, s3
  v_bfe_u32 v13, v11, 2, 2
  v_lshrrev_b32 v14, 4, v11
  v_and_b32 v15, 3, v11
  v_lshl_add_u32 v15, v14, 2, v15
  v_mul_u32_u24 v16, 80, v13
  v_mul_u32_u24 v17, 36, v14
  v_add3_u32 v16, v16, v15, v17
  v_add_u32 v16, 16, v16
  v_mul_u32_u24 v16, 1280, v16
  v_add_u32 v206, v16, v12
  v_add_u32 v10, 128, v1
  v_mul_u32_u24 v11, s52, v10
  v_lshrrev_b32 v11, 16, v11
  v_mul_u32_u24 v12, 10, v11
  v_sub_u32 v12, v10, v12
  v_lshl_add_u32 v12, v12, 4, s3
  v_bfe_u32 v13, v11, 2, 2
  v_lshrrev_b32 v14, 4, v11
  v_and_b32 v15, 3, v11
  v_lshl_add_u32 v15, v14, 2, v15
  v_lshrrev_b32 v17, 1, v13
  v_mul_u32_u24 v17, 24, v17
  v_lshl_add_u32 v16, v13, 3, v15
  v_add_u32 v16, v16, v17
  v_mul_u32_u24 v16, 1280, v16
  v_add_u32 v211, v16, v12
  v_add_u32 v10, 192, v1
  v_mul_u32_u24 v11, s52, v10
  v_lshrrev_b32 v11, 16, v11
  v_mul_u32_u24 v12, 10, v11
  v_sub_u32 v12, v10, v12
  v_lshl_add_u32 v12, v12, 4, s3
  v_bfe_u32 v13, v11, 2, 2
  v_lshrrev_b32 v14, 4, v11
  v_and_b32 v15, 3, v11
  v_lshl_add_u32 v15, v14, 2, v15
  v_mul_u32_u24 v16, 80, v13
  v_mul_u32_u24 v17, 36, v14
  v_add3_u32 v16, v16, v15, v17
  v_add_u32 v16, 16, v16
  v_mul_u32_u24 v16, 1280, v16
  v_add_u32 v207, v16, v12
  v_add_u32 v10, 192, v1
  v_mul_u32_u24 v11, s52, v10
  v_lshrrev_b32 v11, 16, v11
  v_mul_u32_u24 v12, 10, v11
  v_sub_u32 v12, v10, v12
  v_lshl_add_u32 v12, v12, 4, s3
  v_bfe_u32 v13, v11, 2, 2
  v_lshrrev_b32 v14, 4, v11
  v_and_b32 v15, 3, v11
  v_lshl_add_u32 v15, v14, 2, v15
  v_lshrrev_b32 v17, 1, v13
  v_mul_u32_u24 v17, 24, v17
  v_lshl_add_u32 v16, v13, 3, v15
  v_add_u32 v16, v16, v17
  v_mul_u32_u24 v16, 1280, v16
  v_add_u32 v212, v16, v12
  v_add_u32 v10, 256, v1
  v_mul_u32_u24 v11, s52, v10
  v_lshrrev_b32 v11, 16, v11
  v_mul_u32_u24 v12, 10, v11
  v_sub_u32 v12, v10, v12
  v_lshl_add_u32 v12, v12, 4, s3
  v_bfe_u32 v13, v11, 2, 2
  v_lshrrev_b32 v14, 4, v11
  v_and_b32 v15, 3, v11
  v_lshl_add_u32 v15, v14, 2, v15
  v_mul_u32_u24 v16, 80, v13
  v_mul_u32_u24 v17, 36, v14
  v_add3_u32 v16, v16, v15, v17
  v_add_u32 v16, 16, v16
  v_mul_u32_u24 v16, 1280, v16
  v_add_u32 v208, v16, v12
  v_add_u32 v10, 256, v1
  v_mul_u32_u24 v11, s52, v10
  v_lshrrev_b32 v11, 16, v11
  v_mul_u32_u24 v12, 10, v11
  v_sub_u32 v12, v10, v12
  v_lshl_add_u32 v12, v12, 4, s3
  v_bfe_u32 v13, v11, 2, 2
  v_lshrrev_b32 v14, 4, v11
  v_and_b32 v15, 3, v11
  v_lshl_add_u32 v15, v14, 2, v15
  v_lshrrev_b32 v17, 1, v13
  v_mul_u32_u24 v17, 24, v17
  v_lshl_add_u32 v16, v13, 3, v15
  v_add_u32 v16, v16, v17
  v_mul_u32_u24 v16, 1280, v16
  v_add_u32 v213, v16, v12
f_attn:
  v_mov_b32 v116, 0
  v_mov_b32 v117, 0
  v_mov_b32 v118, 0
  v_mov_b32 v119, 0
  v_mov_b32 v120, 0
  v_mov_b32 v121, 0
  v_mov_b32 v122, 0
  v_mov_b32 v123, 0
  v_mov_b32 v124, 0
  v_mov_b32 v125, 0
  v_mov_b32 v126, 0
  v_mov_b32 v127, 0
  v_mov_b32 v128, 0
  v_mov_b32 v129, 0
  v_mov_b32 v130, 0
  v_mov_b32 v131, 0
  v_mov_b32 v132, 0
  v_mov_b32 v133, 0
  v_mov_b32 v134, 0
  v_mov_b32 v135, 0
  v_mov_b32 v136, 0
  v_mov_b32 v137, 0
  v_mov_b32 v138, 0
  v_mov_b32 v139, 0
  v_mov_b32 v140, 0
  v_mov_b32 v141, 0
  v_mov_b32 v142, 0
  v_mov_b32 v143, 0
  v_mov_b32 v144, 0
  v_mov_b32 v145, 0
  v_mov_b32 v146, 0
  v_mov_b32 v147, 0
  v_mov_b32 v148, 0
  v_mov_b32 v149, 0
  v_mov_b32 v150, 0
  v_mov_b32 v151, 0
  v_mov_b32 v152, 0
  v_mov_b32 v153, 0
  v_mov_b32 v154, 0
  v_mov_b32 v155, 0
  v_mov_b32 v156, 0
  v_mov_b32 v157, 0
  v_mov_b32 v158, 0
  v_mov_b32 v159, 0
  v_mov_b32 v160, 0
  v_mov_b32 v161, 0
  v_mov_b32 v162, 0
  v_mov_b32 v163, 0
  v_mov_b32 v164, 0
  v_mov_b32 v165, 0
  v_mov_b32 v166, 0
  v_mov_b32 v167, 0
  v_mov_b32 v168, 0
  v_mov_b32 v169, 0
  v_mov_b32 v170, 0
  v_mov_b32 v171, 0
  v_mov_b32 v172, 0
  v_mov_b32 v173, 0
  v_mov_b32 v174, 0
  v_mov_b32 v175, 0
  v_mov_b32 v176, 0
  v_mov_b32 v177, 0
  v_mov_b32 v178, 0
  v_mov_b32 v179, 0
  v_mov_b32 v108, 0
  v_mov_b32 v109, 0
  v_mov_b32 v110, 0
  v_mov_b32 v111, 0
  v_mov_b32 v112, 0
  v_mov_b32 v113, 0
  v_mov_b32 v114, 0
  v_mov_b32 v115, 0
  v_mov_b32 v236, 0
  v_mov_b32 v237, 0
  v_mov_b32 v238, 0
  v_mov_b32 v239, 0
  v_and_b32 v8, 15, v1
  v_lshlrev_b32 v250, 8, v8
  s_mul_i32 s3, s57, 53
  v_add_u32 v8, s3, v1
  v_min_u32 v8, 209, v8
  v_cmp_lt_u32 vcc, 104, v8
  v_subrev_u32 v9, 105, v8
  s_nop 0
  v_cndmask_b32 v8, v8, v9, vcc
  v_cndmask_b32 v10, 0, 1, vcc
  v_mul_u32_u24 v9, 26880, v10
  v_lshl_add_u32 v251, v8, 4, v9
  s_mov_b32 s3, 0x3334
  v_mul_u32_u24 v9, s3, v8
  v_lshrrev_b32 v9, 16, v9
  v_mul_u32_u24 v17, 5, v9
  v_sub_u32 v8, v8, v17
  v_lshrrev_b32 v17, 1, v8
  v_lshlrev_b32 v17, 9, v17
  v_lshl_add_u32 v17, v9, 4, v17
  v_and_b32 v8, 1, v8
  v_lshl_add_u32 v17, v8, 3, v17
  v_mul_u32_u24 v10, 1536, v10
  v_add_u32 v10, 151552, v10
  v_add_u32 v252, v17, v10
  v_add_u32 v253, 151552, v2
  v_and_b32 v8, 31, v1
  v_lshlrev_b32 v9, 4, v8
  v_add_u32 v254, 151552, v9
  v_lshlrev_b32 v9, 3, v8
  v_mov_b32 v10, 2130706432
  v_cmp_gt_u32 vcc, 32, v1
  s_nop 1
  v_cndmask_b32 v255, v10, v9, vcc
  v_min_u32 v8, 19, v8
  v_mul_u32_u24 v8, 1280, v8
  v_lshrrev_b32 v9, 5, v1
  v_mul_u32_u24 v9, 156, v9
  v_add_u32 v244, v8, v9
  s_mul_i32 s44, s58, 102400
  s_xor_b32 s3, s57, 1
  s_mul_i32 s3, s3, 9216
  s_add_u32 s3, s3, s44
  v_add_u32 v17, s3, v2
  s_xor_b32 s3, s57, 2
  s_mul_i32 s3, s3, 9216
  s_add_u32 s3, s3, s44
  v_add_u32 v18, s3, v2
  s_xor_b32 s3, s57, 3
  s_mul_i32 s3, s3, 9216
  s_add_u32 s3, s3, s44
  v_add_u32 v19, s3, v2
  s_mul_i32 s3, s57, 9216
  s_add_u32 s3, s3, s44
  v_add_u32 v245, s3, v2
  v_and_b32 v8, 31, v1
  v_lshlrev_b32 v11, 2, v8
  v_lshlrev_b32 v12, 3, v8
  v_and_b32 v13, 3, v1
  s_lshl_b32 s3, s59, 6
  s_lshl_b32 s44, s17, 2
  s_add_u32 s3, s3, s44
  s_lshl_b32 s52, s3, 2
  s_add_u32 s52, s52, 12451840
  s_xor_b32 s44, s57, 0
  s_lshl_b32 s46, s44, 14
  s_add_u32 s44, s44, s3
  s_mul_i32 s40, s44, 1408
  s_add_u32 s40, s40, 5636096
  s_xor_b32 s44, s57, 1
  s_lshl_b32 s47, s44, 14
  s_add_u32 s44, s44, s3
  s_mul_i32 s41, s44, 1408
  s_add_u32 s41, s41, 5636096
  s_xor_b32 s44, s57, 2
  s_lshl_b32 s48, s44, 14
  s_add_u32 s44, s44, s3
  s_mul_i32 s42, s44, 1408
  s_add_u32 s42, s42, 5636096
  s_xor_b32 s44, s57, 3
  s_lshl_b32 s49, s44, 14
  s_add_u32 s44, s44, s3
  s_mul_i32 s43, s44, 1408
  s_add_u32 s43, s43, 5636096
  s_mul_i32 s51, s57, 43008
  s_add_u32 s51, s51, s63
  s_mul_i32 s53, s58, 1408
  s_cmp_eq_u32 s98, 0
  s_cbranch_scc1 f_qlds
  v_lshlrev_b32 v13, 2, v13
  s_mov_b32 s64, 0x100000
f_qw_w:
  ds_read_b32 v9, v49 offset:52
  s_sub_u32 s64, s64, 1
  s_waitcnt lgkmcnt(0)
  v_cmp_gt_u32 vcc, 1, v9
  s_cbranch_vccz f_qw_x
  s_sleep 1
  s_cmp_lg_u32 s64, 0
  s_cbranch_scc1 f_qw_w
f_qw_x:
  buffer_load_dword v48, v13, s[12:15], s52 offen sc1
  buffer_load_dword v84, v11, s[12:15], s40 offen offset:1280 sc1
  buffer_load_dword v85, v11, s[12:15], s41 offen offset:1280 sc1
  buffer_load_dword v86, v11, s[12:15], s42 offen offset:1280 sc1
  buffer_load_dword v87, v11, s[12:15], s43 offen offset:1280 sc1
  buffer_load_dwordx2 v[68:69], v12, s[12:15], s40 offen offset:1024 sc1
  buffer_load_dwordx4 v[52:55], v2, s[12:15], s40 offen sc1
  buffer_load_dwordx2 v[70:71], v12, s[12:15], s41 offen offset:1024 sc1
  buffer_load_dwordx4 v[56:59], v2, s[12:15], s41 offen sc1
  buffer_load_dwordx2 v[72:73], v12, s[12:15], s42 offen offset:1024 sc1
  buffer_load_dwordx4 v[60:63], v2, s[12:15], s42 offen sc1
  buffer_load_dwordx2 v[74:75], v12, s[12:15], s43 offen offset:1024 sc1
  buffer_load_dwordx4 v[64:67], v2, s[12:15], s43 offen sc1
  s_branch f_qdone
f_qlds:
  v_lshlrev_b32 v13, 14, v13
  v_add_u32 v13, s53, v13
  v_add_u32 v13, 98304, v13
  s_add_u32 s53, s53, 103424
  s_mov_b32 s64, 0x100000
  s_branch f_q13y
f_q13:
  s_sleep 1
f_q13y:
  ds_read_b32 v248, v246 offset:16
  s_sub_u32 s64, s64, 1
  s_waitcnt lgkmcnt(0)
  v_cmp_gt_u32 vcc, 13, v248
  s_cmp_eq_u32 s64, 0
  s_cbranch_scc1 f_q13x
  s_cbranch_vccnz f_q13
f_q13x:
  ds_read_b32 v48, v13 offset:12156
  s_add_u32 s46, s46, s53
  v_add_u32 v14, s46, v2
  v_add_u32 v15, s46, v12
  v_add_u32 v16, s46, v11
  ds_read_b128 v[52:55], v14
  ds_read_b64 v[68:69], v15 offset:1024
  ds_read_b32 v84, v16 offset:1280
  s_add_u32 s47, s47, s53
  v_add_u32 v14, s47, v2
  v_add_u32 v15, s47, v12
  v_add_u32 v16, s47, v11
  ds_read_b128 v[56:59], v14
  ds_read_b64 v[70:71], v15 offset:1024
  ds_read_b32 v85, v16 offset:1280
  s_add_u32 s48, s48, s53
  v_add_u32 v14, s48, v2
  v_add_u32 v15, s48, v12
  v_add_u32 v16, s48, v11
  ds_read_b128 v[60:63], v14
  ds_read_b64 v[72:73], v15 offset:1024
  ds_read_b32 v86, v16 offset:1280
  s_add_u32 s49, s49, s53
  v_add_u32 v14, s49, v2
  v_add_u32 v15, s49, v12
  v_add_u32 v16, s49, v11
  ds_read_b128 v[64:67], v14
  ds_read_b64 v[74:75], v15 offset:1024
  ds_read_b32 v87, v16 offset:1280
f_qdone:
  s_add_u32 s3, s16, s98
  s_cmp_lg_u32 s3, 0
  s_cbranch_scc1 f_kvn
  s_lshl_b32 s65, s18, 12
  s_add_u32 s65, s65, 17825792
  s_mov_b32 s64, 0x20000
f_pkv_p:
  buffer_load_dword v10, v250, s[12:15], s65 offen sc1
  s_waitcnt vmcnt(0)
  v_cmp_ne_u32 vcc, s19, v10
  s_cbranch_vccz f_pkv_d
  s_sleep 1
  s_sub_u32 s64, s64, 1
  s_cmp_lg_u32 s64, 0
  s_cbranch_scc1 f_pkv_p
f_pkv_d:
  v_mov_b32 v9, 1
  s_mov_b64 exec, 1
  ds_add_u32 v49, v9 offset:28
  s_mov_b64 exec, -1
  s_branch f_kvg
f_kvn:
  s_mov_b32 s64, 0x100000
f_kvw_w:
  ds_read_b32 v9, v49 offset:28
  s_sub_u32 s64, s64, 1
  s_waitcnt lgkmcnt(0)
  v_cmp_gt_u32 vcc, 1, v9
  s_cbranch_vccz f_kvw_x
  s_cmp_lg_u32 s64, 0
  s_cbranch_scc1 f_kvw_w
f_kvw_x:
f_kvg:
  buffer_load_dwordx4 v[20:23], v2, s[12:15], s51 offen sc1
  buffer_load_dwordx2 v[44:45], v3, s[12:15], s51 offen offset:1024 sc1
  buffer_load_dwordx4 v[28:31], v4, s[12:15], s51 offen offset:1280 sc1
  buffer_load_dwordx4 v[36:39], v4, s[12:15], s51 offen offset:1952 sc1
  s_add_u32 s51, s51, 2688
  buffer_load_dwordx4 v[24:27], v2, s[12:15], s51 offen sc1
  buffer_load_dwordx2 v[46:47], v3, s[12:15], s51 offen offset:1024 sc1
  buffer_load_dwordx4 v[32:35], v4, s[12:15], s51 offen offset:1280 sc1
  buffer_load_dwordx4 v[40:43], v4, s[12:15], s51 offen offset:1952 sc1
  s_add_u32 s51, s51, 2688
  buffer_load_dwordx4 v[216:219], v2, s[12:15], s51 offen sc1
  buffer_load_dwordx2 v[240:241], v3, s[12:15], s51 offen offset:1024 sc1
  buffer_load_dwordx4 v[224:227], v4, s[12:15], s51 offen offset:1280 sc1
  buffer_load_dwordx4 v[232:235], v4, s[12:15], s51 offen offset:1952 sc1
  s_add_u32 s51, s51, 2688
  buffer_load_dwordx4 v[220:223], v2, s[12:15], s51 offen sc1
  buffer_load_dwordx2 v[242:243], v3, s[12:15], s51 offen offset:1024 sc1
  buffer_load_dwordx4 v[228:231], v4, s[12:15], s51 offen offset:1280 sc1
  s_waitcnt vmcnt(15) lgkmcnt(0)
  v_mov_b32 v9, 1
  s_mov_b64 exec, 1
  ds_add_u32 v49, v9 offset:0
  s_mov_b64 exec, -1
  v_max_f32_dpp v48, v48, v48 quad_perm:[1,0,3,2] row_mask:0xf bank_mask:0xf
  s_nop 1
  v_max_f32_dpp v48, v48, v48 quad_perm:[2,3,0,1] row_mask:0xf bank_mask:0xf
  v_cmp_gt_u32 vcc, 32, v1
  v_mul_f32 v84, v84, v48
  v_sqrt_f32 v84, v84
  s_nop 0
  v_and_b32 v10, 0xffff0000, v84
  v_sub_f32 v84, v10, v84
  v_xor_b32 v10, 0x80000000, v10
  v_perm_b32 v88, v84, v10, s62
  v_cndmask_b32 v68, v88, v68, vcc
  v_cndmask_b32 v69, 0, v69, vcc
  v_mul_f32 v85, v85, v48
  v_sqrt_f32 v85, v85
  s_nop 0
  v_and_b32 v10, 0xffff0000, v85
  v_sub_f32 v85, v10, v85
  v_xor_b32 v10, 0x80000000, v10
  v_perm_b32 v89, v85, v10, s62
  v_cndmask_b32 v70, v89, v70, vcc
  v_cndmask_b32 v71, 0, v71, vcc
  v_mul_f32 v86, v86, v48
  v_sqrt_f32 v86, v86
  s_nop 0
  v_and_b32 v10, 0xffff0000, v86
  v_sub_f32 v86, v10, v86
  v_xor_b32 v10, 0x80000000, v10
  v_perm_b32 v90, v86, v10, s62
  v_cndmask_b32 v72, v90, v72, vcc
  v_cndmask_b32 v73, 0, v73, vcc
  v_mul_f32 v87, v87, v48
  v_sqrt_f32 v87, v87
  s_nop 0
  v_and_b32 v10, 0xffff0000, v87
  v_sub_f32 v87, v10, v87
  v_xor_b32 v10, 0x80000000, v10
  v_perm_b32 v91, v87, v10, s62
  v_cndmask_b32 v74, v91, v74, vcc
  v_cndmask_b32 v75, 0, v75, vcc
  s_waitcnt vmcnt(11)
  v_mfma_f32_32x32x16_bf16 v[84:99], v[20:23], v[52:55], 0
  v_mfma_f32_32x32x8_bf16 v[84:99], v[44:45], v[68:69], v[84:99]
  s_mov_b32 s54, 4
  s_lshl_b32 s3, s58, 2
  v_add_u32 v10, s3, v49
  v_mov_b32 v12, 1
  s_mov_b32 s55, 0x70000000
  s_setprio 2
  s_cmp_lt_u32 s16, 4
  s_cbranch_scc1 f_np3
  s_setprio 1
  s_cmp_eq_u32 s98, 0
  s_cbranch_scc1 f_bk1
  buffer_store_dwordx4 v[180:183], v76, s[12:15], s99 offen sc1
  buffer_store_dwordx4 v[184:187], v77, s[12:15], s99 offen sc1
  buffer_store_dwordx4 v[188:191], v78, s[12:15], 0 offen sc1
  buffer_store_dwordx4 v[192:195], v79, s[12:15], 0 offen sc1
  buffer_store_dwordx4 v[196:199], v80, s[12:15], 0 offen sc1
  buffer_store_dwordx4 v[200:203], v81, s[12:15], 0 offen sc1
  buffer_store_dwordx4 v[204:207], v82, s[12:15], 0 offen sc1
  buffer_store_dwordx4 v[208:211], v83, s[12:15], 0 offen sc1
  s_waitcnt vmcnt(0)
  v_mov_b32 v9, 1
  s_mov_b64 exec, 1
  ds_add_rtn_u32 v8, v49, v9 offset:32
  s_mov_b64 exec, -1
  s_lshl_b32 s3, s18, 4
  s_add_u32 s3, s3, s17
  s_lshl_b32 s3, s3, 8
  s_add_u32 s3, s3, 17858560
  s_waitcnt lgkmcnt(0)
  v_readfirstlane_b32 s44, v8
  v_mov_b32 v8, s19
  v_mov_b32 v9, 0
  s_nop 1
  s_cmp_lg_u32 s44, 3
  s_cbranch_scc1 f_bk2
  buffer_store_dword v8, v9, s[12:15], s3 offen sc1
f_bk2:
f_bk1:
f_np3:
  s_nop 7
.p2align 6
f_al:
  v_exp_f32 v84, v84
  v_exp_f32 v85, v85
  v_smfmac_f32_32x32x32_bf16 v[164:179], v[236:239], v[108:115], v5
  buffer_load_dwordx4 v[236:239], v4, s[12:15], s51 offen offset:1952 sc1
  s_cmp_eq_u32 s54, 1
  s_cselect_b32 s51, s55, s51
  v_exp_f32 v86, v86
  v_exp_f32 v87, v87
  v_exp_f32 v88, v88
  v_exp_f32 v89, v89
  v_mfma_f32_32x32x16_bf16 v[100:115], v[20:23], v[56:59], 0
  v_exp_f32 v90, v90
  v_exp_f32 v91, v91
  v_exp_f32 v92, v92
  v_exp_f32 v93, v93
  v_mfma_f32_32x32x8_bf16 v[100:115], v[44:45], v[70:71], v[100:115]
  s_nop 0
  v_exp_f32 v94, v94
  v_exp_f32 v95, v95
  v_exp_f32 v96, v96
  v_exp_f32 v97, v97
  v_smfmac_f32_32x32x32_bf16 v[116:131], v[28:31], v[84:91], v5
  s_nop 1
  v_exp_f32 v98, v98
  v_exp_f32 v99, v99
  v_exp_f32 v100, v100
  v_exp_f32 v101, v101
  v_smfmac_f32_32x32x32_bf16 v[116:131], v[36:39], v[92:99], v5
  s_add_u32 s51, s51, 2688
  v_exp_f32 v102, v102
  v_exp_f32 v103, v103
  v_exp_f32 v104, v104
  v_exp_f32 v105, v105
  v_mfma_f32_32x32x16_bf16 v[84:99], v[20:23], v[60:63], 0
  v_exp_f32 v106, v106
  v_exp_f32 v107, v107
  v_exp_f32 v108, v108
  v_exp_f32 v109, v109
  v_mfma_f32_32x32x8_bf16 v[84:99], v[44:45], v[72:73], v[84:99]
  s_nop 0
  v_exp_f32 v110, v110
  v_exp_f32 v111, v111
  v_exp_f32 v112, v112
  v_exp_f32 v113, v113
  v_smfmac_f32_32x32x32_bf16 v[132:147], v[28:31], v[100:107], v5
  s_mov_b64 exec, 1
  ds_add_u32 v10, v12 offset:12
  s_mov_b64 exec, -1
  v_exp_f32 v114, v114
  v_exp_f32 v115, v115
  v_exp_f32 v84, v84
  v_exp_f32 v85, v85
  v_smfmac_f32_32x32x32_bf16 v[132:147], v[36:39], v[108:115], v5
  v_exp_f32 v86, v86
  v_exp_f32 v87, v87
  v_exp_f32 v88, v88
  v_exp_f32 v89, v89
  v_mfma_f32_32x32x16_bf16 v[100:115], v[20:23], v[64:67], 0
  v_exp_f32 v90, v90
  v_exp_f32 v91, v91
  v_exp_f32 v92, v92
  v_exp_f32 v93, v93
  v_mfma_f32_32x32x8_bf16 v[100:115], v[44:45], v[74:75], v[100:115]
  s_nop 0
  v_exp_f32 v94, v94
  v_exp_f32 v95, v95
  v_exp_f32 v96, v96
  v_exp_f32 v97, v97
  v_smfmac_f32_32x32x32_bf16 v[148:163], v[28:31], v[84:91], v5
  buffer_load_dwordx4 v[20:23], v2, s[12:15], s51 offen sc1
  v_exp_f32 v98, v98
  v_exp_f32 v99, v99
  v_exp_f32 v100, v100
  v_exp_f32 v101, v101
  v_smfmac_f32_32x32x32_bf16 v[148:163], v[36:39], v[92:99], v5
  s_waitcnt vmcnt(9)
  buffer_load_dwordx2 v[44:45], v3, s[12:15], s51 offen offset:1024 sc1
  v_exp_f32 v102, v102
  v_exp_f32 v103, v103
  v_exp_f32 v104, v104
  v_exp_f32 v105, v105
  v_mfma_f32_32x32x16_bf16 v[84:99], v[24:27], v[52:55], 0
  v_exp_f32 v106, v106
  v_exp_f32 v107, v107
  v_exp_f32 v108, v108
  v_exp_f32 v109, v109
  v_mfma_f32_32x32x8_bf16 v[84:99], v[46:47], v[68:69], v[84:99]
  s_nop 0
  v_exp_f32 v110, v110
  v_exp_f32 v111, v111
  v_exp_f32 v112, v112
  v_exp_f32 v113, v113
  v_smfmac_f32_32x32x32_bf16 v[164:179], v[28:31], v[100:107], v5
  buffer_load_dwordx4 v[28:31], v4, s[12:15], s51 offen offset:1280 sc1
  v_exp_f32 v114, v114
  v_exp_f32 v115, v115
  v_exp_f32 v84, v84
  v_exp_f32 v85, v85
  v_smfmac_f32_32x32x32_bf16 v[164:179], v[36:39], v[108:115], v5
  buffer_load_dwordx4 v[36:39], v4, s[12:15], s51 offen offset:1952 sc1
  v_exp_f32 v86, v86
  v_exp_f32 v87, v87
  v_exp_f32 v88, v88
  v_exp_f32 v89, v89
  v_mfma_f32_32x32x16_bf16 v[100:115], v[24:27], v[56:59], 0
  v_exp_f32 v90, v90
  v_exp_f32 v91, v91
  v_exp_f32 v92, v92
  v_exp_f32 v93, v93
  v_mfma_f32_32x32x8_bf16 v[100:115], v[46:47], v[70:71], v[100:115]
  s_nop 0
  v_exp_f32 v94, v94
  v_exp_f32 v95, v95
  v_exp_f32 v96, v96
  v_exp_f32 v97, v97
  v_smfmac_f32_32x32x32_bf16 v[116:131], v[32:35], v[84:91], v5
  s_nop 1
  v_exp_f32 v98, v98
  v_exp_f32 v99, v99
  v_exp_f32 v100, v100
  v_exp_f32 v101, v101
  v_smfmac_f32_32x32x32_bf16 v[116:131], v[40:43], v[92:99], v5
  s_add_u32 s51, s51, 2688
  v_exp_f32 v102, v102
  v_exp_f32 v103, v103
  v_exp_f32 v104, v104
  v_exp_f32 v105, v105
  v_mfma_f32_32x32x16_bf16 v[84:99], v[24:27], v[60:63], 0
  v_exp_f32 v106, v106
  v_exp_f32 v107, v107
  v_exp_f32 v108, v108
  v_exp_f32 v109, v109
  v_mfma_f32_32x32x8_bf16 v[84:99], v[46:47], v[72:73], v[84:99]
  s_nop 0
  v_exp_f32 v110, v110
  v_exp_f32 v111, v111
  v_exp_f32 v112, v112
  v_exp_f32 v113, v113
  v_smfmac_f32_32x32x32_bf16 v[132:147], v[32:35], v[100:107], v5
  s_nop 1
  v_exp_f32 v114, v114
  v_exp_f32 v115, v115
  v_exp_f32 v84, v84
  v_exp_f32 v85, v85
  v_smfmac_f32_32x32x32_bf16 v[132:147], v[40:43], v[108:115], v5
  v_exp_f32 v86, v86
  v_exp_f32 v87, v87
  v_exp_f32 v88, v88
  v_exp_f32 v89, v89
  v_mfma_f32_32x32x16_bf16 v[100:115], v[24:27], v[64:67], 0
  v_exp_f32 v90, v90
  v_exp_f32 v91, v91
  v_exp_f32 v92, v92
  v_exp_f32 v93, v93
  v_mfma_f32_32x32x8_bf16 v[100:115], v[46:47], v[74:75], v[100:115]
  s_nop 0
  v_exp_f32 v94, v94
  v_exp_f32 v95, v95
  v_exp_f32 v96, v96
  v_exp_f32 v97, v97
  v_smfmac_f32_32x32x32_bf16 v[148:163], v[32:35], v[84:91], v5
  buffer_load_dwordx4 v[24:27], v2, s[12:15], s51 offen sc1
  v_exp_f32 v98, v98
  v_exp_f32 v99, v99
  v_exp_f32 v100, v100
  v_exp_f32 v101, v101
  v_smfmac_f32_32x32x32_bf16 v[148:163], v[40:43], v[92:99], v5
  s_waitcnt vmcnt(9)
  buffer_load_dwordx2 v[46:47], v3, s[12:15], s51 offen offset:1024 sc1
  v_exp_f32 v102, v102
  v_exp_f32 v103, v103
  v_exp_f32 v104, v104
  v_exp_f32 v105, v105
  v_mfma_f32_32x32x16_bf16 v[84:99], v[216:219], v[52:55], 0
  v_exp_f32 v106, v106
  v_exp_f32 v107, v107
  v_exp_f32 v108, v108
  v_exp_f32 v109, v109
  v_mfma_f32_32x32x8_bf16 v[84:99], v[240:241], v[68:69], v[84:99]
  s_nop 0
  v_exp_f32 v110, v110
  v_exp_f32 v111, v111
  v_exp_f32 v112, v112
  v_exp_f32 v113, v113
  v_smfmac_f32_32x32x32_bf16 v[164:179], v[32:35], v[100:107], v5
  buffer_load_dwordx4 v[32:35], v4, s[12:15], s51 offen offset:1280 sc1
  v_exp_f32 v114, v114
  v_exp_f32 v115, v115
  v_exp_f32 v84, v84
  v_exp_f32 v85, v85
  v_smfmac_f32_32x32x32_bf16 v[164:179], v[40:43], v[108:115], v5
  buffer_load_dwordx4 v[40:43], v4, s[12:15], s51 offen offset:1952 sc1
  v_exp_f32 v86, v86
  v_exp_f32 v87, v87
  v_exp_f32 v88, v88
  v_exp_f32 v89, v89
  v_mfma_f32_32x32x16_bf16 v[100:115], v[216:219], v[56:59], 0
  v_exp_f32 v90, v90
  v_exp_f32 v91, v91
  v_exp_f32 v92, v92
  v_exp_f32 v93, v93
  v_mfma_f32_32x32x8_bf16 v[100:115], v[240:241], v[70:71], v[100:115]
  s_nop 0
  v_exp_f32 v94, v94
  v_exp_f32 v95, v95
  v_exp_f32 v96, v96
  v_exp_f32 v97, v97
  v_smfmac_f32_32x32x32_bf16 v[116:131], v[224:227], v[84:91], v5
  s_nop 1
  v_exp_f32 v98, v98
  v_exp_f32 v99, v99
  v_exp_f32 v100, v100
  v_exp_f32 v101, v101
  v_smfmac_f32_32x32x32_bf16 v[116:131], v[232:235], v[92:99], v5
  s_add_u32 s51, s51, 2688
  v_exp_f32 v102, v102
  v_exp_f32 v103, v103
  v_exp_f32 v104, v104
  v_exp_f32 v105, v105
  v_mfma_f32_32x32x16_bf16 v[84:99], v[216:219], v[60:63], 0
  v_exp_f32 v106, v106
  v_exp_f32 v107, v107
  v_exp_f32 v108, v108
  v_exp_f32 v109, v109
  v_mfma_f32_32x32x8_bf16 v[84:99], v[240:241], v[72:73], v[84:99]
  s_nop 0
  v_exp_f32 v110, v110
  v_exp_f32 v111, v111
  v_exp_f32 v112, v112
  v_exp_f32 v113, v113
  v_smfmac_f32_32x32x32_bf16 v[132:147], v[224:227], v[100:107], v5
  s_nop 1
  v_exp_f32 v114, v114
  v_exp_f32 v115, v115
  v_exp_f32 v84, v84
  v_exp_f32 v85, v85
  v_smfmac_f32_32x32x32_bf16 v[132:147], v[232:235], v[108:115], v5
  v_exp_f32 v86, v86
  v_exp_f32 v87, v87
  v_exp_f32 v88, v88
  v_exp_f32 v89, v89
  v_mfma_f32_32x32x16_bf16 v[100:115], v[216:219], v[64:67], 0
  v_exp_f32 v90, v90
  v_exp_f32 v91, v91
  v_exp_f32 v92, v92
  v_exp_f32 v93, v93
  v_mfma_f32_32x32x8_bf16 v[100:115], v[240:241], v[74:75], v[100:115]
  s_nop 0
  v_exp_f32 v94, v94
  v_exp_f32 v95, v95
  v_exp_f32 v96, v96
  v_exp_f32 v97, v97
  v_smfmac_f32_32x32x32_bf16 v[148:163], v[224:227], v[84:91], v5
  buffer_load_dwordx4 v[216:219], v2, s[12:15], s51 offen sc1
  v_exp_f32 v98, v98
  v_exp_f32 v99, v99
  v_exp_f32 v100, v100
  v_exp_f32 v101, v101
  v_smfmac_f32_32x32x32_bf16 v[148:163], v[232:235], v[92:99], v5
  s_waitcnt vmcnt(9)
  buffer_load_dwordx2 v[240:241], v3, s[12:15], s51 offen offset:1024 sc1
  v_exp_f32 v102, v102
  v_exp_f32 v103, v103
  v_exp_f32 v104, v104
  v_exp_f32 v105, v105
  v_mfma_f32_32x32x16_bf16 v[84:99], v[220:223], v[52:55], 0
  v_exp_f32 v106, v106
  v_exp_f32 v107, v107
  v_exp_f32 v108, v108
  v_exp_f32 v109, v109
  v_mfma_f32_32x32x8_bf16 v[84:99], v[242:243], v[68:69], v[84:99]
  s_nop 0
  v_exp_f32 v110, v110
  v_exp_f32 v111, v111
  v_exp_f32 v112, v112
  v_exp_f32 v113, v113
  v_smfmac_f32_32x32x32_bf16 v[164:179], v[224:227], v[100:107], v5
  buffer_load_dwordx4 v[224:227], v4, s[12:15], s51 offen offset:1280 sc1
  v_exp_f32 v114, v114
  v_exp_f32 v115, v115
  v_exp_f32 v84, v84
  v_exp_f32 v85, v85
  v_smfmac_f32_32x32x32_bf16 v[164:179], v[232:235], v[108:115], v5
  buffer_load_dwordx4 v[232:235], v4, s[12:15], s51 offen offset:1952 sc1
  v_exp_f32 v86, v86
  v_exp_f32 v87, v87
  v_exp_f32 v88, v88
  v_exp_f32 v89, v89
  v_mfma_f32_32x32x16_bf16 v[100:115], v[220:223], v[56:59], 0
  v_exp_f32 v90, v90
  v_exp_f32 v91, v91
  v_exp_f32 v92, v92
  v_exp_f32 v93, v93
  v_mfma_f32_32x32x8_bf16 v[100:115], v[242:243], v[70:71], v[100:115]
  s_nop 0
  v_exp_f32 v94, v94
  v_exp_f32 v95, v95
  v_exp_f32 v96, v96
  v_exp_f32 v97, v97
  v_smfmac_f32_32x32x32_bf16 v[116:131], v[228:231], v[84:91], v5
  s_nop 1
  v_exp_f32 v98, v98
  v_exp_f32 v99, v99
  v_exp_f32 v100, v100
  v_exp_f32 v101, v101
  v_smfmac_f32_32x32x32_bf16 v[116:131], v[236:239], v[92:99], v5
  s_add_u32 s51, s51, 2688
  s_sub_u32 s54, s54, 1
  v_exp_f32 v102, v102
  v_exp_f32 v103, v103
  v_exp_f32 v104, v104
  v_exp_f32 v105, v105
  v_mfma_f32_32x32x16_bf16 v[84:99], v[220:223], v[60:63], 0
  v_exp_f32 v106, v106
  v_exp_f32 v107, v107
  v_exp_f32 v108, v108
  v_exp_f32 v109, v109
  v_mfma_f32_32x32x8_bf16 v[84:99], v[242:243], v[72:73], v[84:99]
  ds_read_b32 v9, v49
  v_exp_f32 v110, v110
  v_exp_f32 v111, v111
  v_exp_f32 v112, v112
  v_exp_f32 v113, v113
  v_smfmac_f32_32x32x32_bf16 v[132:147], v[228:231], v[100:107], v5
  s_nop 1
  v_exp_f32 v114, v114
  v_exp_f32 v115, v115
  v_exp_f32 v84, v84
  v_exp_f32 v85, v85
  v_smfmac_f32_32x32x32_bf16 v[132:147], v[236:239], v[108:115], v5
  v_exp_f32 v86, v86
  v_exp_f32 v87, v87
  v_exp_f32 v88, v88
  v_exp_f32 v89, v89
  v_mfma_f32_32x32x16_bf16 v[100:115], v[220:223], v[64:67], 0
  v_exp_f32 v90, v90
  v_exp_f32 v91, v91
  v_exp_f32 v92, v92
  v_exp_f32 v93, v93
  v_mfma_f32_32x32x8_bf16 v[100:115], v[242:243], v[74:75], v[100:115]
  s_nop 0
  v_exp_f32 v94, v94
  v_exp_f32 v95, v95
  v_exp_f32 v96, v96
  v_exp_f32 v97, v97
  v_smfmac_f32_32x32x32_bf16 v[148:163], v[228:231], v[84:91], v5
  buffer_load_dwordx4 v[220:223], v2, s[12:15], s51 offen sc1
  v_exp_f32 v98, v98
  v_exp_f32 v99, v99
  v_exp_f32 v100, v100
  v_exp_f32 v101, v101
  v_smfmac_f32_32x32x32_bf16 v[148:163], v[236:239], v[92:99], v5
  s_waitcnt vmcnt(9)
  buffer_load_dwordx2 v[242:243], v3, s[12:15], s51 offen offset:1024 sc1
  v_exp_f32 v102, v102
  v_exp_f32 v103, v103
  v_exp_f32 v104, v104
  v_exp_f32 v105, v105
  v_mfma_f32_32x32x16_bf16 v[84:99], v[20:23], v[52:55], 0
  v_exp_f32 v106, v106
  v_exp_f32 v107, v107
  v_exp_f32 v108, v108
  v_exp_f32 v109, v109
  v_mfma_f32_32x32x8_bf16 v[84:99], v[44:45], v[68:69], v[84:99]
  s_nop 0
  v_exp_f32 v110, v110
  v_exp_f32 v111, v111
  v_exp_f32 v112, v112
  v_exp_f32 v113, v113
  v_smfmac_f32_32x32x32_bf16 v[164:179], v[228:231], v[100:107], v5
  buffer_load_dwordx4 v[228:231], v4, s[12:15], s51 offen offset:1280 sc1
  s_cmp_lg_u32 s54, 0
  v_exp_f32 v114, v114
  v_exp_f32 v115, v115
  s_cbranch_scc1 f_al
  s_nop 1
  v_smfmac_f32_32x32x32_bf16 v[164:179], v[236:239], v[108:115], v5
  s_setprio 3
  s_cmp_ge_u32 s16, 4
  s_cbranch_scc1 f_nwp
  s_setprio 1
  s_and_b32 s3, s17, 7
  s_lshl_b32 s3, s3, 2
  s_add_u32 s3, s3, s57
  s_mul_i32 s3, s3, 25600
  s_mul_i32 s44, s18, 160
  s_add_u32 s3, s3, s44
f_nwp:
  s_lshl_b32 s3, s58, 2
  v_add_u32 v16, s3, v49
  s_waitcnt lgkmcnt(0)
  v_cmp_gt_u32 vcc, 12, v9
  s_cbranch_vccz f_rd_x
  s_mov_b32 s64, 0x100000
f_rd_w:
  ds_read_b32 v9, v49 offset:0
  s_sub_u32 s64, s64, 1
  s_waitcnt lgkmcnt(0)
  v_cmp_gt_u32 vcc, 12, v9
  s_cbranch_vccz f_rd_x
  s_sleep 1
  s_cmp_lg_u32 s64, 0
  s_cbranch_scc1 f_rd_w
f_rd_x:
  ds_write_b128 v17, v[132:135] offset:0
  ds_write_b128 v17, v[136:139] offset:1024
  ds_write_b128 v17, v[140:143] offset:2048
  ds_write_b128 v18, v[148:151] offset:3072
  ds_write_b128 v18, v[152:155] offset:4096
  ds_write_b128 v18, v[156:159] offset:5120
  ds_write_b128 v19, v[164:167] offset:6144
  ds_write_b128 v19, v[168:171] offset:7168
  ds_write_b128 v19, v[172:175] offset:8192
  v_mov_b32 v9, 1
  s_mov_b64 exec, 1
  ds_add_u32 v16, v9 offset:4
  s_mov_b64 exec, -1
  s_mov_b32 s46, 12582912
  s_mov_b32 s47, 15204352
  s_mov_b32 s64, 0x100000
f_m1_w:
  ds_read_b32 v9, v16 offset:4
  s_sub_u32 s64, s64, 1
  s_waitcnt lgkmcnt(0)
  v_cmp_gt_u32 vcc, 4, v9
  s_cbranch_vccz f_m1_x
  s_cmp_lg_u32 s64, 0
  s_cbranch_scc1 f_m1_w
f_m1_x:
  ds_read_b128 v[132:135], v245 offset:0
  ds_read_b128 v[136:139], v245 offset:1024
  ds_read_b128 v[140:143], v245 offset:2048
  ds_read_b128 v[144:147], v245 offset:3072
  ds_read_b128 v[148:151], v245 offset:4096
  ds_read_b128 v[152:155], v245 offset:5120
  ds_read_b128 v[156:159], v245 offset:6144
  ds_read_b128 v[160:163], v245 offset:7168
  ds_read_b128 v[164:167], v245 offset:8192
  s_waitcnt lgkmcnt(3)
  v_pk_add_f32 v[116:117], v[116:117], v[132:133]
  v_pk_add_f32 v[118:119], v[118:119], v[134:135]
  v_pk_add_f32 v[120:121], v[120:121], v[136:137]
  v_pk_add_f32 v[122:123], v[122:123], v[138:139]
  v_pk_add_f32 v[124:125], v[124:125], v[140:141]
  v_pk_add_f32 v[126:127], v[126:127], v[142:143]
  v_pk_add_f32 v[116:117], v[116:117], v[144:145]
  v_pk_add_f32 v[118:119], v[118:119], v[146:147]
  v_pk_add_f32 v[120:121], v[120:121], v[148:149]
  v_pk_add_f32 v[122:123], v[122:123], v[150:151]
  v_pk_add_f32 v[124:125], v[124:125], v[152:153]
  v_pk_add_f32 v[126:127], v[126:127], v[154:155]
  s_waitcnt lgkmcnt(0)
  v_pk_add_f32 v[116:117], v[116:117], v[156:157]
  v_pk_add_f32 v[118:119], v[118:119], v[158:159]
  v_pk_add_f32 v[120:121], v[120:121], v[160:161]
  v_pk_add_f32 v[122:123], v[122:123], v[162:163]
  v_pk_add_f32 v[124:125], v[124:125], v[164:165]
  v_pk_add_f32 v[126:127], v[126:127], v[166:167]
  v_mov_b32 v14, v124
  v_mov_b32 v15, v124
  s_nop 1
  v_permlane32_swap_b32 v14, v15
  v_cmp_nle_f32 vcc, 562036736, v15
  v_mov_b32 v14, 1568669696
  v_cmp_nle_f32 s[66:67], v15, v14
  s_nop 3
  s_or_b64 vcc, vcc, s[66:67]
  s_cbranch_vccnz f_slow
f_fin:
  v_rcp_f32 v15, v15
  s_nop 0
  v_mov_b32 v14, v15
  v_pk_mul_f32 v[116:117], v[116:117], v[14:15]
  v_pk_mul_f32 v[118:119], v[118:119], v[14:15]
  v_pk_mul_f32 v[120:121], v[120:121], v[14:15]
  v_pk_mul_f32 v[122:123], v[122:123], v[14:15]
  v_pk_mul_f32 v[124:125], v[124:125], v[14:15]
  v_pk_mul_f32 v[126:127], v[126:127], v[14:15]
  v_cvt_pk_bf16_f32 v108, v116, v117
  v_cvt_pk_bf16_f32 v109, v118, v119
  v_cvt_pk_bf16_f32 v110, v120, v121
  v_cvt_pk_bf16_f32 v111, v122, v123
  v_cvt_pk_bf16_f32 v112, v124, v125
  v_cvt_pk_bf16_f32 v113, v126, v127
  v_permlane32_swap_b32 v108, v110
  v_permlane32_swap_b32 v109, v111
  buffer_store_dwordx4 v[108:111], v6, s[12:15], s46 offen sc1
  buffer_store_dwordx2 v[112:113], v7, s[12:15], s46 offen offset:0 sc1
  s_cmp_ge_u32 s16, 4
  s_cbranch_scc1 f_pub
  s_mov_b32 s64, 0x100000
f_kl_w:
  ds_read_b32 v9, v49 offset:16
  s_sub_u32 s64, s64, 1
  s_waitcnt lgkmcnt(0)
  v_cmp_gt_u32 vcc, 4, v9
  s_cbranch_vccz f_kl_x
  s_sleep 4
  s_cmp_lg_u32 s64, 0
  s_cbranch_scc1 f_kl_w
f_kl_x:
  s_lshl_b32 s44, s18, 12
  s_add_u32 s44, s44, 17858560
  s_mov_b32 s64, 0x20000
f_pb_p:
  buffer_load_dword v8, v250, s[12:15], s44 offen sc1
  s_waitcnt vmcnt(0)
  v_cmp_ne_u32 vcc, s19, v8
  s_cbranch_vccz f_pb_d
  s_sleep 4
  s_sub_u32 s64, s64, 1
  s_cmp_lg_u32 s64, 0
  s_cbranch_scc1 f_pb_p
f_pb_d:
  s_mul_i32 s3, s59, 26880
  s_add_u32 s3, s3, 11534336
  buffer_load_dwordx4 v[180:183], v251, s[12:15], s3 offen offset:0 sc1
  buffer_load_dwordx4 v[184:187], v251, s[12:15], s3 offen offset:1680 sc1
  s_add_u32 s3, s3, 3360
  buffer_load_dwordx4 v[188:191], v251, s[12:15], s3 offen offset:0 sc1
  buffer_load_dwordx4 v[192:195], v251, s[12:15], s3 offen offset:1680 sc1
  s_add_u32 s3, s3, 3360
  buffer_load_dwordx4 v[196:199], v251, s[12:15], s3 offen offset:0 sc1
  buffer_load_dwordx4 v[200:203], v251, s[12:15], s3 offen offset:1680 sc1
  s_add_u32 s3, s3, 3360
  buffer_load_dwordx4 v[216:219], v251, s[12:15], s3 offen offset:0 sc1
  buffer_load_dwordx4 v[220:223], v251, s[12:15], s3 offen offset:1680 sc1
  s_add_u32 s3, s3, 3360
  buffer_load_dwordx4 v[224:227], v251, s[12:15], s3 offen offset:0 sc1
  buffer_load_dwordx4 v[228:231], v251, s[12:15], s3 offen offset:1680 sc1
  s_add_u32 s3, s3, 3360
  buffer_load_dwordx4 v[232:235], v251, s[12:15], s3 offen offset:0 sc1
  buffer_load_dwordx4 v[236:239], v251, s[12:15], s3 offen offset:1680 sc1
  s_add_u32 s3, s3, 3360
  buffer_load_dwordx4 v[240:243], v251, s[12:15], s3 offen offset:0 sc1
  buffer_load_dwordx4 v[84:87], v251, s[12:15], s3 offen offset:1680 sc1
  s_add_u32 s3, s3, 3360
  buffer_load_dwordx4 v[88:91], v251, s[12:15], s3 offen offset:0 sc1
  buffer_load_dwordx4 v[92:95], v251, s[12:15], s3 offen offset:1680 sc1
  s_add_u32 s40, s40, 2883584
  buffer_load_dwordx4 v[56:59], v2, s[12:15], s40 offen sc1
  buffer_load_dwordx2 v[64:65], v255, s[12:15], s40 offen offset:1024 sc1
  s_add_u32 s40, s40, 90112
  buffer_load_dwordx4 v[60:63], v2, s[12:15], s40 offen sc1
  buffer_load_dwordx2 v[66:67], v255, s[12:15], s40 offen offset:1024 sc1
  s_waitcnt vmcnt(0)
  v_pk_add_f32 v[180:181], v[180:181], v[224:225]
  v_pk_add_f32 v[182:183], v[182:183], v[226:227]
  v_pk_add_f32 v[184:185], v[184:185], v[228:229]
  v_pk_add_f32 v[186:187], v[186:187], v[230:231]
  v_pk_add_f32 v[188:189], v[188:189], v[232:233]
  v_pk_add_f32 v[190:191], v[190:191], v[234:235]
  v_pk_add_f32 v[192:193], v[192:193], v[236:237]
  v_pk_add_f32 v[194:195], v[194:195], v[238:239]
  v_pk_add_f32 v[196:197], v[196:197], v[240:241]
  v_pk_add_f32 v[198:199], v[198:199], v[242:243]
  v_pk_add_f32 v[200:201], v[200:201], v[84:85]
  v_pk_add_f32 v[202:203], v[202:203], v[86:87]
  v_pk_add_f32 v[216:217], v[216:217], v[88:89]
  v_pk_add_f32 v[218:219], v[218:219], v[90:91]
  v_pk_add_f32 v[220:221], v[220:221], v[92:93]
  v_pk_add_f32 v[222:223], v[222:223], v[94:95]
  v_pk_add_f32 v[180:181], v[180:181], v[196:197]
  v_pk_add_f32 v[182:183], v[182:183], v[198:199]
  v_pk_add_f32 v[184:185], v[184:185], v[200:201]
  v_pk_add_f32 v[186:187], v[186:187], v[202:203]
  v_pk_add_f32 v[188:189], v[188:189], v[216:217]
  v_pk_add_f32 v[190:191], v[190:191], v[218:219]
  v_pk_add_f32 v[192:193], v[192:193], v[220:221]
  v_pk_add_f32 v[194:195], v[194:195], v[222:223]
  v_pk_add_f32 v[180:181], v[180:181], v[188:189]
  v_pk_add_f32 v[182:183], v[182:183], v[190:191]
  v_pk_add_f32 v[184:185], v[184:185], v[192:193]
  v_pk_add_f32 v[186:187], v[186:187], v[194:195]
  v_pk_add_f32 v[180:181], v[180:181], v[184:185]
  v_pk_add_f32 v[182:183], v[182:183], v[186:187]
  v_cvt_pk_bf16_f32 v180, v180, v181
  v_cvt_pk_bf16_f32 v181, v182, v183
  ds_write_b64 v252, v[180:181]
  v_mov_b32 v9, 1
  s_mov_b64 exec, 1
  ds_add_u32 v49, v9 offset:20
  s_mov_b64 exec, -1
  s_mov_b32 s64, 0x100000
f_g_w:
  ds_read_b32 v9, v49 offset:20
  s_sub_u32 s64, s64, 1
  s_waitcnt lgkmcnt(0)
  v_cmp_gt_u32 vcc, 4, v9
  s_cbranch_vccz f_g_x
  s_sleep 1
  s_cmp_lg_u32 s64, 0
  s_cbranch_scc1 f_g_w
f_g_x:
  ds_read_b128 v[20:23], v253 offset:0
  ds_read_b64 v[44:45], v254 offset:1024
  ds_read_b128 v[24:27], v253 offset:1536
  ds_read_b64 v[46:47], v254 offset:2560
  s_waitcnt lgkmcnt(0)
  v_mfma_f32_32x32x16_bf16 v[116:131], v[20:23], v[56:59], 0
  v_mfma_f32_32x32x8_bf16 v[116:131], v[44:45], v[64:65], v[116:131]
  v_mfma_f32_32x32x16_bf16 v[132:147], v[24:27], v[60:63], 0
  v_mfma_f32_32x32x8_bf16 v[132:147], v[46:47], v[66:67], v[132:147]
  s_nop 9
  v_mov_b32 v14, v124
  v_mov_b32 v15, v124
  s_nop 1
  v_permlane32_swap_b32 v14, v15
  v_add_f32 v15, s96, v15
  v_rcp_f32 v15, v15
  s_nop 0
  v_mov_b32 v14, v15
  v_pk_mul_f32 v[116:117], v[116:117], v[14:15]
  v_pk_mul_f32 v[118:119], v[118:119], v[14:15]
  v_pk_mul_f32 v[120:121], v[120:121], v[14:15]
  v_pk_mul_f32 v[122:123], v[122:123], v[14:15]
  v_pk_mul_f32 v[124:125], v[124:125], v[14:15]
  v_pk_mul_f32 v[126:127], v[126:127], v[14:15]
  v_cvt_pk_bf16_f32 v84, v116, v117
  v_cvt_pk_bf16_f32 v85, v118, v119
  v_cvt_pk_bf16_f32 v86, v120, v121
  v_cvt_pk_bf16_f32 v87, v122, v123
  v_cvt_pk_bf16_f32 v88, v124, v125
  v_cvt_pk_bf16_f32 v89, v126, v127
  v_permlane32_swap_b32 v84, v86
  v_permlane32_swap_b32 v85, v87
  buffer_store_dwordx4 v[84:87], v6, s[12:15], s47 offen sc1
  buffer_store_dwordx2 v[88:89], v7, s[12:15], s47 offen offset:0 sc1
  v_mov_b32 v14, v140
  v_mov_b32 v15, v140
  s_nop 1
  v_permlane32_swap_b32 v14, v15
  v_add_f32 v15, s96, v15
  s_add_u32 s46, s47, 8192
  v_rcp_f32 v15, v15
  s_nop 0
  v_mov_b32 v14, v15
  v_pk_mul_f32 v[132:133], v[132:133], v[14:15]
  v_pk_mul_f32 v[134:135], v[134:135], v[14:15]
  v_pk_mul_f32 v[136:137], v[136:137], v[14:15]
  v_pk_mul_f32 v[138:139], v[138:139], v[14:15]
  v_pk_mul_f32 v[140:141], v[140:141], v[14:15]
  v_pk_mul_f32 v[142:143], v[142:143], v[14:15]
  v_cvt_pk_bf16_f32 v92, v132, v133
  v_cvt_pk_bf16_f32 v93, v134, v135
  v_cvt_pk_bf16_f32 v94, v136, v137
  v_cvt_pk_bf16_f32 v95, v138, v139
  v_cvt_pk_bf16_f32 v96, v140, v141
  v_cvt_pk_bf16_f32 v97, v142, v143
  v_permlane32_swap_b32 v92, v94
  v_permlane32_swap_b32 v93, v95
  buffer_store_dwordx4 v[92:95], v6, s[12:15], s46 offen sc1
  buffer_store_dwordx2 v[96:97], v7, s[12:15], s47 offen offset:2048 sc1
f_pub:
  v_lshrrev_b32 v10, 2, v1
  v_mul_u32_u24 v10, 160, v10
  v_and_b32 v11, 3, v1
  v_lshl_add_u32 v16, v11, 3, v10
  v_add_u32 v17, 81920, v16
  v_and_b32 v10, 15, v1
  v_lshrrev_b32 v11, 4, v1
  v_lshlrev_b32 v18, 3, v10
  v_lshl_add_u32 v18, v11, 8, v18
  v_mul_u32_u24 v10, 160, v10
  v_lshl_add_u32 v19, v11, 3, v10
  s_lshl_b32 s3, s98, 7
  s_lshl_b32 s46, s17, 2
  s_add_u32 s46, s46, s57
  s_lshl_b32 s46, s46, 1
  s_add_u32 s46, s46, s58
  s_add_u32 s3, s3, s46
  s_mul_i32 s50, s3, 20480
  s_add_u32 s50, s50, 12582912
  s_lshl_b32 s3, s58, 2
  v_add_u32 v15, s3, v49
  s_lshl_b32 s65, s17, 12
  s_lshl_b32 s3, s58, 16
  s_add_u32 s65, s65, s3
  s_add_u32 s65, s65, 18022400
  s_mul_i32 s3, s57, 6144
  s_add_u32 s44, s3, 102400
  v_add_u32 v10, s44, v2
  s_waitcnt vmcnt(0)
  v_mov_b32 v9, 1
  s_mov_b64 exec, 1
  ds_add_rtn_u32 v8, v15, v9 offset:44
  s_mov_b64 exec, -1
  s_waitcnt lgkmcnt(0)
  v_readfirstlane_b32 s45, v8
  s_nop 3
  s_cmp_lg_u32 s45, 3
  s_cbranch_scc1 f_rel
  s_lshl_b32 s3, s98, 3
  s_add_u32 s3, s3, s18
  s_lshl_b32 s3, s3, 8
  s_add_u32 s3, s3, s65
  v_mov_b32 v8, s19
  v_mov_b32 v9, 0
  buffer_store_dword v8, v9, s[12:15], s3 offen sc1
f_rel:
  s_cmp_ge_u32 s16, 4
  s_cbranch_scc1 f_hi
  s_mov_b32 s64, 0x100000
f_wl_w:
  ds_read_b32 v9, v49 offset:16
  s_sub_u32 s64, s64, 1
  s_waitcnt lgkmcnt(0)
  v_cmp_gt_u32 vcc, 16, v9
  s_cbranch_vccz f_wl_x
  s_sleep 4
  s_cmp_lg_u32 s64, 0
  s_cbranch_scc1 f_wl_w
f_wl_x:
  s_setprio 0
  s_mul_i32 s40, s57, 20480
  s_and_b32 s41, s57, 1
  s_lshr_b32 s3, s57, 1
  s_mul_i32 s42, s41, 320
  s_mul_i32 s3, s3, 20
  s_add_u32 s42, s42, s3
  s_mul_i32 s41, s42, 1280
  s_mov_b32 s42, s41
  s_mov_b32 m0, s40
  s_nop 0
  buffer_load_dwordx4 v209, s[20:23], s41 offen lds
  s_add_u32 m0, m0, 1024
  s_nop 0
  buffer_load_dwordx4 v210, s[20:23], s41 offen lds
  s_add_u32 m0, m0, 1024
  s_nop 0
  buffer_load_dwordx4 v211, s[20:23], s41 offen lds
  s_add_u32 m0, m0, 1024
  s_nop 0
  buffer_load_dwordx4 v212, s[20:23], s41 offen lds
  s_add_u32 m0, m0, 1024
  s_nop 0
  buffer_load_dwordx4 v213, s[20:23], s41 offen lds
  s_add_u32 m0, m0, 1024
  s_add_u32 s41, s41, 102400
  buffer_load_dwordx4 v209, s[20:23], s41 offen lds
  s_add_u32 m0, m0, 1024
  s_nop 0
  buffer_load_dwordx4 v210, s[20:23], s41 offen lds
  s_add_u32 m0, m0, 1024
  s_nop 0
  buffer_load_dwordx4 v211, s[20:23], s41 offen lds
  s_add_u32 m0, m0, 1024
  s_nop 0
  buffer_load_dwordx4 v212, s[20:23], s41 offen lds
  s_add_u32 m0, m0, 1024
  s_nop 0
  buffer_load_dwordx4 v213, s[20:23], s41 offen lds
  s_add_u32 m0, m0, 1024
  s_add_u32 s41, s41, 102400
  buffer_load_dwordx4 v209, s[20:23], s41 offen lds
  s_add_u32 m0, m0, 1024
  s_nop 0
  buffer_load_dwordx4 v210, s[20:23], s41 offen lds
  s_add_u32 m0, m0, 1024
  s_nop 0
  buffer_load_dwordx4 v211, s[20:23], s41 offen lds
  s_add_u32 m0, m0, 1024
  s_nop 0
  buffer_load_dwordx4 v212, s[20:23], s41 offen lds
  s_add_u32 m0, m0, 1024
  s_nop 0
  buffer_load_dwordx4 v213, s[20:23], s41 offen lds
  s_add_u32 m0, m0, 1024
  s_add_u32 s41, s41, 102400
  buffer_load_dwordx4 v209, s[20:23], s41 offen lds
  s_add_u32 m0, m0, 1024
  s_nop 0
  buffer_load_dwordx4 v210, s[20:23], s41 offen lds
  s_add_u32 m0, m0, 1024
  s_nop 0
  buffer_load_dwordx4 v211, s[20:23], s41 offen lds
  s_add_u32 m0, m0, 1024
  s_nop 0
  buffer_load_dwordx4 v212, s[20:23], s41 offen lds
  s_add_u32 m0, m0, 1024
  s_nop 0
  buffer_load_dwordx4 v213, s[20:23], s41 offen lds
  s_add_u32 m0, m0, 1024
  s_add_u32 s41, s41, 102400
  s_mul_i32 s3, s57, 5120
  s_add_u32 m0, s3, 81920
  s_nop 0
  buffer_load_dwordx4 v204, s[20:23], s42 offen lds
  s_add_u32 m0, m0, 1024
  s_nop 0
  buffer_load_dwordx4 v205, s[20:23], s42 offen lds
  s_add_u32 m0, m0, 1024
  s_nop 0
  buffer_load_dwordx4 v206, s[20:23], s42 offen lds
  s_add_u32 m0, m0, 1024
  s_nop 0
  buffer_load_dwordx4 v207, s[20:23], s42 offen lds
  s_add_u32 m0, m0, 1024
  s_nop 0
  buffer_load_dwordx4 v208, s[20:23], s42 offen lds
  s_add_u32 m0, m0, 1024
  s_nop 0
  s_setprio 0
  v_mov_b32 v164, 0
  v_mov_b32 v165, 0
  v_mov_b32 v166, 0
  v_mov_b32 v167, 0
  v_mov_b32 v168, 0
  v_mov_b32 v169, 0
  v_mov_b32 v170, 0
  v_mov_b32 v171, 0
  v_mov_b32 v172, 0
  v_mov_b32 v173, 0
  v_mov_b32 v174, 0
  v_mov_b32 v175, 0
  v_mov_b32 v176, 0
  v_mov_b32 v177, 0
  v_mov_b32 v178, 0
  v_mov_b32 v179, 0
  v_mov_b32 v180, 0
  v_mov_b32 v181, 0
  v_mov_b32 v182, 0
  v_mov_b32 v183, 0
  v_mov_b32 v184, 0
  v_mov_b32 v185, 0
  v_mov_b32 v186, 0
  v_mov_b32 v187, 0
  v_mov_b32 v188, 0
  v_mov_b32 v189, 0
  v_mov_b32 v190, 0
  v_mov_b32 v191, 0
  v_mov_b32 v192, 0
  v_mov_b32 v193, 0
  v_mov_b32 v194, 0
  v_mov_b32 v195, 0
  v_mov_b32 v196, 0
  v_mov_b32 v197, 0
  v_mov_b32 v198, 0
  v_mov_b32 v199, 0
  v_mov_b32 v200, 0
  v_mov_b32 v201, 0
  v_mov_b32 v202, 0
  v_mov_b32 v203, 0
  s_add_u32 s51, s50, 20480
  s_add_u32 s52, s50, 16384
  s_add_u32 s53, s51, 16384
  s_waitcnt vmcnt(0)
  s_cmp_lg_u32 s45, 3
  s_cbranch_scc1 f_p0n
  s_mov_b32 s64, 0x20000
f_po0_p:
  buffer_load_dword v9, v250, s[12:15], s65 offen sc1
  s_waitcnt vmcnt(0)
  v_cmp_ne_u32 vcc, s19, v9
  s_cbranch_vccz f_po0_d
  s_sleep 2
  s_sub_u32 s64, s64, 1
  s_cmp_lg_u32 s64, 0
  s_cbranch_scc1 f_po0_p
f_po0_d:
f_p0n:
  v_mov_b32 v9, 1
  s_mov_b64 exec, 1
  ds_add_u32 v49, v9 offset:24
  s_mov_b64 exec, -1
  s_mov_b32 s64, 0x100000
f_wok_w:
  ds_read_b32 v9, v49 offset:24
  s_sub_u32 s64, s64, 1
  s_waitcnt lgkmcnt(0)
  v_cmp_gt_u32 vcc, 4, v9
  s_cbranch_vccz f_wok_x
  s_sleep 1
  s_cmp_lg_u32 s64, 0
  s_cbranch_scc1 f_wok_w
f_wok_x:
  s_mov_b32 s54, s50
  buffer_load_dwordx4 v[52:55], v2, s[12:15], s54 offen offset:0 sc1
  buffer_load_dwordx4 v[56:59], v2, s[12:15], s51 offen offset:0 sc1
  buffer_load_dwordx4 v[60:63], v2, s[12:15], s54 offen offset:1024 sc1
  buffer_load_dwordx4 v[64:67], v2, s[12:15], s51 offen offset:1024 sc1
  buffer_load_dwordx4 v[68:71], v2, s[12:15], s54 offen offset:2048 sc1
  buffer_load_dwordx4 v[72:75], v2, s[12:15], s51 offen offset:2048 sc1
  buffer_load_dwordx4 v[76:79], v2, s[12:15], s54 offen offset:3072 sc1
  buffer_load_dwordx4 v[80:83], v2, s[12:15], s51 offen offset:3072 sc1
  s_add_u32 s54, s54, 4096
  s_add_u32 s51, s51, 4096
  buffer_load_dwordx4 v[84:87], v2, s[12:15], s54 offen offset:0 sc1
  buffer_load_dwordx4 v[88:91], v2, s[12:15], s51 offen offset:0 sc1
  buffer_load_dwordx4 v[92:95], v2, s[12:15], s54 offen offset:1024 sc1
  buffer_load_dwordx4 v[96:99], v2, s[12:15], s51 offen offset:1024 sc1
  buffer_load_dwordx4 v[100:103], v2, s[12:15], s54 offen offset:2048 sc1
  buffer_load_dwordx4 v[104:107], v2, s[12:15], s51 offen offset:2048 sc1
  buffer_load_dwordx4 v[108:111], v2, s[12:15], s54 offen offset:3072 sc1
  buffer_load_dwordx4 v[112:115], v2, s[12:15], s51 offen offset:3072 sc1
  buffer_load_dwordx2 v[116:117], v18, s[12:15], s52 offen offset:0 sc1
  buffer_load_dwordx2 v[118:119], v18, s[12:15], s52 offen offset:128 sc1
  buffer_load_dwordx2 v[120:121], v18, s[12:15], s53 offen offset:0 sc1
  buffer_load_dwordx2 v[122:123], v18, s[12:15], s53 offen offset:128 sc1
  buffer_load_dwordx2 v[124:125], v18, s[12:15], s52 offen offset:1024 sc1
  buffer_load_dwordx2 v[126:127], v18, s[12:15], s52 offen offset:1152 sc1
  buffer_load_dwordx2 v[128:129], v18, s[12:15], s53 offen offset:1024 sc1
  buffer_load_dwordx2 v[130:131], v18, s[12:15], s53 offen offset:1152 sc1
  ds_read_b64_tr_b16 v[132:133], v16 offset:0
  ds_read_b64_tr_b16 v[134:135], v16 offset:2560
  ds_read_b64_tr_b16 v[136:137], v16 offset:32
  ds_read_b64_tr_b16 v[138:139], v16 offset:2592
  ds_read_b64_tr_b16 v[140:141], v16 offset:64
  ds_read_b64_tr_b16 v[142:143], v16 offset:2624
  ds_read_b64_tr_b16 v[144:145], v16 offset:96
  ds_read_b64_tr_b16 v[146:147], v16 offset:2656
  ds_read_b64_tr_b16 v[148:149], v16 offset:128
  ds_read_b64_tr_b16 v[150:151], v16 offset:2688
  ds_read_b64_tr_b16 v[152:153], v16 offset:5120
  ds_read_b64_tr_b16 v[154:155], v16 offset:7680
  s_waitcnt vmcnt(22)
  s_waitcnt lgkmcnt(8)
  v_mfma_f32_16x16x32_bf16 v[164:167], v[132:135], v[52:55], v[164:167]
  ds_read_b64_tr_b16 v[156:157], v16 offset:5152
  v_mfma_f32_16x16x32_bf16 v[184:187], v[132:135], v[56:59], v[184:187]
  ds_read_b64_tr_b16 v[158:159], v16 offset:7712
  v_mfma_f32_16x16x32_bf16 v[168:171], v[136:139], v[52:55], v[168:171]
  ds_read_b64_tr_b16 v[160:161], v16 offset:5184
  v_mfma_f32_16x16x32_bf16 v[188:191], v[136:139], v[56:59], v[188:191]
  ds_read_b64_tr_b16 v[162:163], v16 offset:7744
  s_waitcnt lgkmcnt(8)
  v_mfma_f32_16x16x32_bf16 v[172:175], v[140:143], v[52:55], v[172:175]
  ds_read_b64_tr_b16 v[132:133], v16 offset:5216
  v_mfma_f32_16x16x32_bf16 v[192:195], v[140:143], v[56:59], v[192:195]
  ds_read_b64_tr_b16 v[134:135], v16 offset:7776
  v_mfma_f32_16x16x32_bf16 v[176:179], v[144:147], v[52:55], v[176:179]
  ds_read_b64_tr_b16 v[136:137], v16 offset:5248
  v_mfma_f32_16x16x32_bf16 v[196:199], v[144:147], v[56:59], v[196:199]
  ds_read_b64_tr_b16 v[138:139], v16 offset:7808
  s_waitcnt lgkmcnt(8)
  v_mfma_f32_16x16x32_bf16 v[180:183], v[148:151], v[52:55], v[180:183]
  ds_read_b64_tr_b16 v[140:141], v16 offset:10240
  v_mfma_f32_16x16x32_bf16 v[200:203], v[148:151], v[56:59], v[200:203]
  ds_read_b64_tr_b16 v[142:143], v16 offset:12800
  s_waitcnt vmcnt(20)
  v_mfma_f32_16x16x32_bf16 v[164:167], v[152:155], v[60:63], v[164:167]
  ds_read_b64_tr_b16 v[144:145], v16 offset:10272
  v_mfma_f32_16x16x32_bf16 v[184:187], v[152:155], v[64:67], v[184:187]
  ds_read_b64_tr_b16 v[146:147], v16 offset:12832
  s_waitcnt lgkmcnt(8)
  v_mfma_f32_16x16x32_bf16 v[168:171], v[156:159], v[60:63], v[168:171]
  ds_read_b64_tr_b16 v[148:149], v16 offset:10304
  v_mfma_f32_16x16x32_bf16 v[188:191], v[156:159], v[64:67], v[188:191]
  ds_read_b64_tr_b16 v[150:151], v16 offset:12864
  v_mfma_f32_16x16x32_bf16 v[172:175], v[160:163], v[60:63], v[172:175]
  ds_read_b64_tr_b16 v[152:153], v16 offset:10336
  v_mfma_f32_16x16x32_bf16 v[192:195], v[160:163], v[64:67], v[192:195]
  ds_read_b64_tr_b16 v[154:155], v16 offset:12896
  s_waitcnt lgkmcnt(8)
  v_mfma_f32_16x16x32_bf16 v[176:179], v[132:135], v[60:63], v[176:179]
  ds_read_b64_tr_b16 v[156:157], v16 offset:10368
  v_mfma_f32_16x16x32_bf16 v[196:199], v[132:135], v[64:67], v[196:199]
  ds_read_b64_tr_b16 v[158:159], v16 offset:12928
  v_mfma_f32_16x16x32_bf16 v[180:183], v[136:139], v[60:63], v[180:183]
  ds_read_b64_tr_b16 v[160:161], v16 offset:15360
  v_mfma_f32_16x16x32_bf16 v[200:203], v[136:139], v[64:67], v[200:203]
  ds_read_b64_tr_b16 v[162:163], v16 offset:17920
  s_waitcnt vmcnt(18)
  s_waitcnt lgkmcnt(8)
  v_mfma_f32_16x16x32_bf16 v[164:167], v[140:143], v[68:71], v[164:167]
  ds_read_b64_tr_b16 v[132:133], v16 offset:15392
  v_mfma_f32_16x16x32_bf16 v[184:187], v[140:143], v[72:75], v[184:187]
  ds_read_b64_tr_b16 v[134:135], v16 offset:17952
  v_mfma_f32_16x16x32_bf16 v[168:171], v[144:147], v[68:71], v[168:171]
  ds_read_b64_tr_b16 v[136:137], v16 offset:15424
  v_mfma_f32_16x16x32_bf16 v[188:191], v[144:147], v[72:75], v[188:191]
  ds_read_b64_tr_b16 v[138:139], v16 offset:17984
  s_waitcnt lgkmcnt(8)
  v_mfma_f32_16x16x32_bf16 v[172:175], v[148:151], v[68:71], v[172:175]
  ds_read_b64_tr_b16 v[140:141], v16 offset:15456
  v_mfma_f32_16x16x32_bf16 v[192:195], v[148:151], v[72:75], v[192:195]
  ds_read_b64_tr_b16 v[142:143], v16 offset:18016
  v_mfma_f32_16x16x32_bf16 v[176:179], v[152:155], v[68:71], v[176:179]
  ds_read_b64_tr_b16 v[144:145], v16 offset:15488
  v_mfma_f32_16x16x32_bf16 v[196:199], v[152:155], v[72:75], v[196:199]
  ds_read_b64_tr_b16 v[146:147], v16 offset:18048
  s_waitcnt lgkmcnt(8)
  v_mfma_f32_16x16x32_bf16 v[180:183], v[156:159], v[68:71], v[180:183]
  ds_read_b64_tr_b16 v[148:149], v16 offset:20480
  v_mfma_f32_16x16x32_bf16 v[200:203], v[156:159], v[72:75], v[200:203]
  ds_read_b64_tr_b16 v[150:151], v16 offset:23040
  s_waitcnt vmcnt(16)
  v_mfma_f32_16x16x32_bf16 v[164:167], v[160:163], v[76:79], v[164:167]
  ds_read_b64_tr_b16 v[152:153], v16 offset:20512
  v_mfma_f32_16x16x32_bf16 v[184:187], v[160:163], v[80:83], v[184:187]
  ds_read_b64_tr_b16 v[154:155], v16 offset:23072
  s_waitcnt lgkmcnt(8)
  v_mfma_f32_16x16x32_bf16 v[168:171], v[132:135], v[76:79], v[168:171]
  ds_read_b64_tr_b16 v[156:157], v16 offset:20544
  v_mfma_f32_16x16x32_bf16 v[188:191], v[132:135], v[80:83], v[188:191]
  ds_read_b64_tr_b16 v[158:159], v16 offset:23104
  v_mfma_f32_16x16x32_bf16 v[172:175], v[136:139], v[76:79], v[172:175]
  ds_read_b64_tr_b16 v[160:161], v16 offset:20576
  v_mfma_f32_16x16x32_bf16 v[192:195], v[136:139], v[80:83], v[192:195]
  ds_read_b64_tr_b16 v[162:163], v16 offset:23136
  s_waitcnt lgkmcnt(8)
  v_mfma_f32_16x16x32_bf16 v[176:179], v[140:143], v[76:79], v[176:179]
  ds_read_b64_tr_b16 v[132:133], v16 offset:20608
  v_mfma_f32_16x16x32_bf16 v[196:199], v[140:143], v[80:83], v[196:199]
  ds_read_b64_tr_b16 v[134:135], v16 offset:23168
  v_mfma_f32_16x16x32_bf16 v[180:183], v[144:147], v[76:79], v[180:183]
  ds_read_b64_tr_b16 v[136:137], v16 offset:25600
  v_mfma_f32_16x16x32_bf16 v[200:203], v[144:147], v[80:83], v[200:203]
  ds_read_b64_tr_b16 v[138:139], v16 offset:28160
  s_waitcnt vmcnt(14)
  s_waitcnt lgkmcnt(8)
  v_mfma_f32_16x16x32_bf16 v[164:167], v[148:151], v[84:87], v[164:167]
  ds_read_b64_tr_b16 v[140:141], v16 offset:25632
  v_mfma_f32_16x16x32_bf16 v[184:187], v[148:151], v[88:91], v[184:187]
  ds_read_b64_tr_b16 v[142:143], v16 offset:28192
  v_mfma_f32_16x16x32_bf16 v[168:171], v[152:155], v[84:87], v[168:171]
  ds_read_b64_tr_b16 v[144:145], v16 offset:25664
  v_mfma_f32_16x16x32_bf16 v[188:191], v[152:155], v[88:91], v[188:191]
  ds_read_b64_tr_b16 v[146:147], v16 offset:28224
  s_waitcnt lgkmcnt(8)
  v_mfma_f32_16x16x32_bf16 v[172:175], v[156:159], v[84:87], v[172:175]
  ds_read_b64_tr_b16 v[148:149], v16 offset:25696
  v_mfma_f32_16x16x32_bf16 v[192:195], v[156:159], v[88:91], v[192:195]
  ds_read_b64_tr_b16 v[150:151], v16 offset:28256
  v_mfma_f32_16x16x32_bf16 v[176:179], v[160:163], v[84:87], v[176:179]
  ds_read_b64_tr_b16 v[152:153], v16 offset:25728
  v_mfma_f32_16x16x32_bf16 v[196:199], v[160:163], v[88:91], v[196:199]
  ds_read_b64_tr_b16 v[154:155], v16 offset:28288
  s_waitcnt lgkmcnt(8)
  v_mfma_f32_16x16x32_bf16 v[180:183], v[132:135], v[84:87], v[180:183]
  ds_read_b64_tr_b16 v[156:157], v16 offset:30720
  v_mfma_f32_16x16x32_bf16 v[200:203], v[132:135], v[88:91], v[200:203]
  ds_read_b64_tr_b16 v[158:159], v16 offset:33280
  s_waitcnt vmcnt(12)
  v_mfma_f32_16x16x32_bf16 v[164:167], v[136:139], v[92:95], v[164:167]
  ds_read_b64_tr_b16 v[160:161], v16 offset:30752
  v_mfma_f32_16x16x32_bf16 v[184:187], v[136:139], v[96:99], v[184:187]
  ds_read_b64_tr_b16 v[162:163], v16 offset:33312
  s_waitcnt lgkmcnt(8)
  v_mfma_f32_16x16x32_bf16 v[168:171], v[140:143], v[92:95], v[168:171]
  ds_read_b64_tr_b16 v[132:133], v16 offset:30784
  v_mfma_f32_16x16x32_bf16 v[188:191], v[140:143], v[96:99], v[188:191]
  ds_read_b64_tr_b16 v[134:135], v16 offset:33344
  v_mfma_f32_16x16x32_bf16 v[172:175], v[144:147], v[92:95], v[172:175]
  ds_read_b64_tr_b16 v[136:137], v16 offset:30816
  v_mfma_f32_16x16x32_bf16 v[192:195], v[144:147], v[96:99], v[192:195]
  ds_read_b64_tr_b16 v[138:139], v16 offset:33376
  s_waitcnt lgkmcnt(8)
  v_mfma_f32_16x16x32_bf16 v[176:179], v[148:151], v[92:95], v[176:179]
  ds_read_b64_tr_b16 v[140:141], v16 offset:30848
  v_mfma_f32_16x16x32_bf16 v[196:199], v[148:151], v[96:99], v[196:199]
  ds_read_b64_tr_b16 v[142:143], v16 offset:33408
  v_mfma_f32_16x16x32_bf16 v[180:183], v[152:155], v[92:95], v[180:183]
  ds_read_b64_tr_b16 v[144:145], v16 offset:35840
  v_mfma_f32_16x16x32_bf16 v[200:203], v[152:155], v[96:99], v[200:203]
  ds_read_b64_tr_b16 v[146:147], v16 offset:38400
  s_waitcnt vmcnt(10)
  s_waitcnt lgkmcnt(8)
  v_mfma_f32_16x16x32_bf16 v[164:167], v[156:159], v[100:103], v[164:167]
  ds_read_b64_tr_b16 v[148:149], v16 offset:35872
  v_mfma_f32_16x16x32_bf16 v[184:187], v[156:159], v[104:107], v[184:187]
  ds_read_b64_tr_b16 v[150:151], v16 offset:38432
  v_mfma_f32_16x16x32_bf16 v[168:171], v[160:163], v[100:103], v[168:171]
  ds_read_b64_tr_b16 v[152:153], v16 offset:35904
  v_mfma_f32_16x16x32_bf16 v[188:191], v[160:163], v[104:107], v[188:191]
  ds_read_b64_tr_b16 v[154:155], v16 offset:38464
  s_waitcnt lgkmcnt(8)
  v_mfma_f32_16x16x32_bf16 v[172:175], v[132:135], v[100:103], v[172:175]
  ds_read_b64_tr_b16 v[156:157], v16 offset:35936
  v_mfma_f32_16x16x32_bf16 v[192:195], v[132:135], v[104:107], v[192:195]
  ds_read_b64_tr_b16 v[158:159], v16 offset:38496
  v_mfma_f32_16x16x32_bf16 v[176:179], v[136:139], v[100:103], v[176:179]
  ds_read_b64_tr_b16 v[160:161], v16 offset:35968
  v_mfma_f32_16x16x32_bf16 v[196:199], v[136:139], v[104:107], v[196:199]
  ds_read_b64_tr_b16 v[162:163], v16 offset:38528
  s_waitcnt lgkmcnt(8)
  v_mfma_f32_16x16x32_bf16 v[180:183], v[140:143], v[100:103], v[180:183]
  ds_read_b64_tr_b16 v[132:133], v17 offset:0
  v_mfma_f32_16x16x32_bf16 v[200:203], v[140:143], v[104:107], v[200:203]
  ds_read_b64_tr_b16 v[134:135], v17 offset:2560
  s_waitcnt vmcnt(8)
  v_mfma_f32_16x16x32_bf16 v[164:167], v[144:147], v[108:111], v[164:167]
  ds_read_b64_tr_b16 v[136:137], v17 offset:32
  v_mfma_f32_16x16x32_bf16 v[184:187], v[144:147], v[112:115], v[184:187]
  ds_read_b64_tr_b16 v[138:139], v17 offset:2592
  s_waitcnt lgkmcnt(8)
  v_mfma_f32_16x16x32_bf16 v[168:171], v[148:151], v[108:111], v[168:171]
  ds_read_b64_tr_b16 v[140:141], v17 offset:64
  v_mfma_f32_16x16x32_bf16 v[188:191], v[148:151], v[112:115], v[188:191]
  ds_read_b64_tr_b16 v[142:143], v17 offset:2624
  v_mfma_f32_16x16x32_bf16 v[172:175], v[152:155], v[108:111], v[172:175]
  ds_read_b64_tr_b16 v[144:145], v17 offset:96
  v_mfma_f32_16x16x32_bf16 v[192:195], v[152:155], v[112:115], v[192:195]
  ds_read_b64_tr_b16 v[146:147], v17 offset:2656
  s_waitcnt lgkmcnt(8)
  v_mfma_f32_16x16x32_bf16 v[176:179], v[156:159], v[108:111], v[176:179]
  ds_read_b64_tr_b16 v[148:149], v17 offset:128
  v_mfma_f32_16x16x32_bf16 v[196:199], v[156:159], v[112:115], v[196:199]
  ds_read_b64_tr_b16 v[150:151], v17 offset:2688
  v_mfma_f32_16x16x32_bf16 v[180:183], v[160:163], v[108:111], v[180:183]
  ds_read_b64_tr_b16 v[152:153], v17 offset:5120
  v_mfma_f32_16x16x32_bf16 v[200:203], v[160:163], v[112:115], v[200:203]
  ds_read_b64_tr_b16 v[154:155], v17 offset:7680
  s_waitcnt vmcnt(4)
  s_waitcnt lgkmcnt(8)
  v_mfma_f32_16x16x32_bf16 v[164:167], v[132:135], v[116:119], v[164:167]
  ds_read_b64_tr_b16 v[156:157], v17 offset:5152
  v_mfma_f32_16x16x32_bf16 v[184:187], v[132:135], v[120:123], v[184:187]
  ds_read_b64_tr_b16 v[158:159], v17 offset:7712
  v_mfma_f32_16x16x32_bf16 v[168:171], v[136:139], v[116:119], v[168:171]
  ds_read_b64_tr_b16 v[160:161], v17 offset:5184
  v_mfma_f32_16x16x32_bf16 v[188:191], v[136:139], v[120:123], v[188:191]
  ds_read_b64_tr_b16 v[162:163], v17 offset:7744
  s_waitcnt lgkmcnt(8)
  v_mfma_f32_16x16x32_bf16 v[172:175], v[140:143], v[116:119], v[172:175]
  ds_read_b64_tr_b16 v[132:133], v17 offset:5216
  v_mfma_f32_16x16x32_bf16 v[192:195], v[140:143], v[120:123], v[192:195]
  ds_read_b64_tr_b16 v[134:135], v17 offset:7776
  v_mfma_f32_16x16x32_bf16 v[176:179], v[144:147], v[116:119], v[176:179]
  ds_read_b64_tr_b16 v[136:137], v17 offset:5248
  v_mfma_f32_16x16x32_bf16 v[196:199], v[144:147], v[120:123], v[196:199]
  ds_read_b64_tr_b16 v[138:139], v17 offset:7808
  s_waitcnt lgkmcnt(8)
  v_mfma_f32_16x16x32_bf16 v[180:183], v[148:151], v[116:119], v[180:183]
  v_mfma_f32_16x16x32_bf16 v[200:203], v[148:151], v[120:123], v[200:203]
  s_waitcnt vmcnt(0)
  v_mfma_f32_16x16x32_bf16 v[164:167], v[152:155], v[124:127], v[164:167]
  v_mfma_f32_16x16x32_bf16 v[184:187], v[152:155], v[128:131], v[184:187]
  s_waitcnt lgkmcnt(4)
  v_mfma_f32_16x16x32_bf16 v[168:171], v[156:159], v[124:127], v[168:171]
  v_mfma_f32_16x16x32_bf16 v[188:191], v[156:159], v[128:131], v[188:191]
  v_mfma_f32_16x16x32_bf16 v[172:175], v[160:163], v[124:127], v[172:175]
  v_mfma_f32_16x16x32_bf16 v[192:195], v[160:163], v[128:131], v[192:195]
  s_waitcnt lgkmcnt(0)
  v_mfma_f32_16x16x32_bf16 v[176:179], v[132:135], v[124:127], v[176:179]
  v_mfma_f32_16x16x32_bf16 v[196:199], v[132:135], v[128:131], v[196:199]
  v_mfma_f32_16x16x32_bf16 v[180:183], v[136:139], v[124:127], v[180:183]
  v_mfma_f32_16x16x32_bf16 v[200:203], v[136:139], v[128:131], v[200:203]
  s_setprio 1
  s_mov_b32 s3, 0x199a
  s_mul_i32 s48, s18, 160
  s_mul_i32 s47, s98, 1280
  s_add_u32 s48, s48, s47
  s_mul_i32 s46, s46, 40960
  s_add_u32 s48, s48, s46
  v_add_u32 v8, 0, v1
  v_mul_u32_u24 v9, s3, v8
  v_lshrrev_b32 v9, 16, v9
  v_mul_u32_u24 v9, 2400, v9
  v_lshl_add_u32 v11, v8, 4, v9
  v_add_u32 v8, 64, v1
  v_mul_u32_u24 v9, s3, v8
  v_lshrrev_b32 v9, 16, v9
  v_mul_u32_u24 v9, 2400, v9
  v_lshl_add_u32 v12, v8, 4, v9
  v_add_u32 v8, 128, v1
  v_mul_u32_u24 v9, s3, v8
  v_lshrrev_b32 v9, 16, v9
  v_mul_u32_u24 v9, 2400, v9
  v_lshl_add_u32 v13, v8, 4, v9
  v_add_u32 v8, 192, v1
  v_mul_u32_u24 v9, s3, v8
  v_lshrrev_b32 v9, 16, v9
  v_mul_u32_u24 v9, 2400, v9
  v_lshl_add_u32 v14, v8, 4, v9
  v_add_u32 v8, 256, v1
  v_mul_u32_u24 v9, s3, v8
  v_lshrrev_b32 v9, 16, v9
  v_mul_u32_u24 v9, 2400, v9
  v_lshl_add_u32 v15, v8, 4, v9
  v_add_u32 v19, s44, v19
  v_add_u32 v16, 40960, v16
  v_add_u32 v17, 10240, v17
  s_add_u32 s54, s50, 8192
  s_add_u32 s51, s54, 20480
  s_add_u32 s52, s52, 2048
  s_add_u32 s53, s53, 2048
  ds_read_b64_tr_b16 v[132:133], v16 offset:0
  ds_read_b64_tr_b16 v[134:135], v16 offset:2560
  ds_read_b64_tr_b16 v[136:137], v16 offset:32
  ds_read_b64_tr_b16 v[138:139], v16 offset:2592
  ds_read_b64_tr_b16 v[140:141], v16 offset:64
  ds_read_b64_tr_b16 v[142:143], v16 offset:2624
  ds_read_b64_tr_b16 v[144:145], v16 offset:96
  ds_read_b64_tr_b16 v[146:147], v16 offset:2656
  ds_read_b64_tr_b16 v[148:149], v16 offset:128
  ds_read_b64_tr_b16 v[150:151], v16 offset:2688
  ds_read_b64_tr_b16 v[152:153], v16 offset:5120
  ds_read_b64_tr_b16 v[154:155], v16 offset:7680
  s_mov_b32 s64, 0x100000
f_o1w_w:
  ds_read_b32 v9, v49 offset:56
  s_sub_u32 s64, s64, 1
  s_waitcnt lgkmcnt(0)
  v_cmp_gt_u32 vcc, 1, v9
  s_cbranch_vccz f_o1w_x
  s_cmp_lg_u32 s64, 0
  s_cbranch_scc1 f_o1w_w
f_o1w_x:
  buffer_load_dwordx4 v[52:55], v2, s[12:15], s54 offen offset:0 sc1
  buffer_load_dwordx4 v[56:59], v2, s[12:15], s51 offen offset:0 sc1
  buffer_load_dwordx4 v[60:63], v2, s[12:15], s54 offen offset:1024 sc1
  buffer_load_dwordx4 v[64:67], v2, s[12:15], s51 offen offset:1024 sc1
  buffer_load_dwordx4 v[68:71], v2, s[12:15], s54 offen offset:2048 sc1
  buffer_load_dwordx4 v[72:75], v2, s[12:15], s51 offen offset:2048 sc1
  buffer_load_dwordx4 v[76:79], v2, s[12:15], s54 offen offset:3072 sc1
  buffer_load_dwordx4 v[80:83], v2, s[12:15], s51 offen offset:3072 sc1
  s_add_u32 s54, s54, 4096
  s_add_u32 s51, s51, 4096
  buffer_load_dwordx4 v[84:87], v2, s[12:15], s54 offen offset:0 sc1
  buffer_load_dwordx4 v[88:91], v2, s[12:15], s51 offen offset:0 sc1
  buffer_load_dwordx4 v[92:95], v2, s[12:15], s54 offen offset:1024 sc1
  buffer_load_dwordx4 v[96:99], v2, s[12:15], s51 offen offset:1024 sc1
  buffer_load_dwordx4 v[100:103], v2, s[12:15], s54 offen offset:2048 sc1
  buffer_load_dwordx4 v[104:107], v2, s[12:15], s51 offen offset:2048 sc1
  buffer_load_dwordx4 v[108:111], v2, s[12:15], s54 offen offset:3072 sc1
  buffer_load_dwordx4 v[112:115], v2, s[12:15], s51 offen offset:3072 sc1
  buffer_load_dwordx2 v[116:117], v18, s[12:15], s52 offen offset:0 sc1
  buffer_load_dwordx2 v[118:119], v18, s[12:15], s52 offen offset:128 sc1
  buffer_load_dwordx2 v[120:121], v18, s[12:15], s53 offen offset:0 sc1
  buffer_load_dwordx2 v[122:123], v18, s[12:15], s53 offen offset:128 sc1
  buffer_load_dwordx2 v[124:125], v18, s[12:15], s52 offen offset:1024 sc1
  buffer_load_dwordx2 v[126:127], v18, s[12:15], s52 offen offset:1152 sc1
  buffer_load_dwordx2 v[128:129], v18, s[12:15], s53 offen offset:1024 sc1
  buffer_load_dwordx2 v[130:131], v18, s[12:15], s53 offen offset:1152 sc1
  s_waitcnt vmcnt(22)
  s_waitcnt lgkmcnt(8)
  v_mfma_f32_16x16x32_bf16 v[164:167], v[132:135], v[52:55], v[164:167]
  ds_read_b64_tr_b16 v[156:157], v16 offset:5152
  v_mfma_f32_16x16x32_bf16 v[184:187], v[132:135], v[56:59], v[184:187]
  ds_read_b64_tr_b16 v[158:159], v16 offset:7712
  v_mfma_f32_16x16x32_bf16 v[168:171], v[136:139], v[52:55], v[168:171]
  ds_read_b64_tr_b16 v[160:161], v16 offset:5184
  v_mfma_f32_16x16x32_bf16 v[188:191], v[136:139], v[56:59], v[188:191]
  ds_read_b64_tr_b16 v[162:163], v16 offset:7744
  s_waitcnt lgkmcnt(8)
  v_mfma_f32_16x16x32_bf16 v[172:175], v[140:143], v[52:55], v[172:175]
  ds_read_b64_tr_b16 v[132:133], v16 offset:5216
  v_mfma_f32_16x16x32_bf16 v[192:195], v[140:143], v[56:59], v[192:195]
  ds_read_b64_tr_b16 v[134:135], v16 offset:7776
  v_mfma_f32_16x16x32_bf16 v[176:179], v[144:147], v[52:55], v[176:179]
  ds_read_b64_tr_b16 v[136:137], v16 offset:5248
  v_mfma_f32_16x16x32_bf16 v[196:199], v[144:147], v[56:59], v[196:199]
  ds_read_b64_tr_b16 v[138:139], v16 offset:7808
  s_waitcnt lgkmcnt(8)
  v_mfma_f32_16x16x32_bf16 v[180:183], v[148:151], v[52:55], v[180:183]
  ds_read_b64_tr_b16 v[140:141], v16 offset:10240
  v_mfma_f32_16x16x32_bf16 v[200:203], v[148:151], v[56:59], v[200:203]
  ds_read_b64_tr_b16 v[142:143], v16 offset:12800
  s_waitcnt vmcnt(20)
  v_mfma_f32_16x16x32_bf16 v[164:167], v[152:155], v[60:63], v[164:167]
  ds_read_b64_tr_b16 v[144:145], v16 offset:10272
  v_mfma_f32_16x16x32_bf16 v[184:187], v[152:155], v[64:67], v[184:187]
  ds_read_b64_tr_b16 v[146:147], v16 offset:12832
  s_waitcnt lgkmcnt(8)
  v_mfma_f32_16x16x32_bf16 v[168:171], v[156:159], v[60:63], v[168:171]
  ds_read_b64_tr_b16 v[148:149], v16 offset:10304
  v_mfma_f32_16x16x32_bf16 v[188:191], v[156:159], v[64:67], v[188:191]
  ds_read_b64_tr_b16 v[150:151], v16 offset:12864
  v_mfma_f32_16x16x32_bf16 v[172:175], v[160:163], v[60:63], v[172:175]
  ds_read_b64_tr_b16 v[152:153], v16 offset:10336
  v_mfma_f32_16x16x32_bf16 v[192:195], v[160:163], v[64:67], v[192:195]
  ds_read_b64_tr_b16 v[154:155], v16 offset:12896
  s_waitcnt lgkmcnt(8)
  v_mfma_f32_16x16x32_bf16 v[176:179], v[132:135], v[60:63], v[176:179]
  ds_read_b64_tr_b16 v[156:157], v16 offset:10368
  v_mfma_f32_16x16x32_bf16 v[196:199], v[132:135], v[64:67], v[196:199]
  ds_read_b64_tr_b16 v[158:159], v16 offset:12928
  v_mfma_f32_16x16x32_bf16 v[180:183], v[136:139], v[60:63], v[180:183]
  ds_read_b64_tr_b16 v[160:161], v16 offset:15360
  v_mfma_f32_16x16x32_bf16 v[200:203], v[136:139], v[64:67], v[200:203]
  ds_read_b64_tr_b16 v[162:163], v16 offset:17920
  s_waitcnt vmcnt(18)
  s_waitcnt lgkmcnt(8)
  v_mfma_f32_16x16x32_bf16 v[164:167], v[140:143], v[68:71], v[164:167]
  ds_read_b64_tr_b16 v[132:133], v16 offset:15392
  v_mfma_f32_16x16x32_bf16 v[184:187], v[140:143], v[72:75], v[184:187]
  ds_read_b64_tr_b16 v[134:135], v16 offset:17952
  v_mfma_f32_16x16x32_bf16 v[168:171], v[144:147], v[68:71], v[168:171]
  ds_read_b64_tr_b16 v[136:137], v16 offset:15424
  v_mfma_f32_16x16x32_bf16 v[188:191], v[144:147], v[72:75], v[188:191]
  ds_read_b64_tr_b16 v[138:139], v16 offset:17984
  s_waitcnt lgkmcnt(8)
  v_mfma_f32_16x16x32_bf16 v[172:175], v[148:151], v[68:71], v[172:175]
  ds_read_b64_tr_b16 v[140:141], v16 offset:15456
  v_mfma_f32_16x16x32_bf16 v[192:195], v[148:151], v[72:75], v[192:195]
  ds_read_b64_tr_b16 v[142:143], v16 offset:18016
  v_mfma_f32_16x16x32_bf16 v[176:179], v[152:155], v[68:71], v[176:179]
  ds_read_b64_tr_b16 v[144:145], v16 offset:15488
  v_mfma_f32_16x16x32_bf16 v[196:199], v[152:155], v[72:75], v[196:199]
  ds_read_b64_tr_b16 v[146:147], v16 offset:18048
  s_waitcnt lgkmcnt(8)
  v_mfma_f32_16x16x32_bf16 v[180:183], v[156:159], v[68:71], v[180:183]
  ds_read_b64_tr_b16 v[148:149], v16 offset:20480
  v_mfma_f32_16x16x32_bf16 v[200:203], v[156:159], v[72:75], v[200:203]
  ds_read_b64_tr_b16 v[150:151], v16 offset:23040
  s_waitcnt vmcnt(16)
  v_mfma_f32_16x16x32_bf16 v[164:167], v[160:163], v[76:79], v[164:167]
  ds_read_b64_tr_b16 v[152:153], v16 offset:20512
  v_mfma_f32_16x16x32_bf16 v[184:187], v[160:163], v[80:83], v[184:187]
  ds_read_b64_tr_b16 v[154:155], v16 offset:23072
  s_waitcnt lgkmcnt(8)
  v_mfma_f32_16x16x32_bf16 v[168:171], v[132:135], v[76:79], v[168:171]
  ds_read_b64_tr_b16 v[156:157], v16 offset:20544
  v_mfma_f32_16x16x32_bf16 v[188:191], v[132:135], v[80:83], v[188:191]
  ds_read_b64_tr_b16 v[158:159], v16 offset:23104
  v_mfma_f32_16x16x32_bf16 v[172:175], v[136:139], v[76:79], v[172:175]
  ds_read_b64_tr_b16 v[160:161], v16 offset:20576
  v_mfma_f32_16x16x32_bf16 v[192:195], v[136:139], v[80:83], v[192:195]
  ds_read_b64_tr_b16 v[162:163], v16 offset:23136
  s_waitcnt lgkmcnt(8)
  v_mfma_f32_16x16x32_bf16 v[176:179], v[140:143], v[76:79], v[176:179]
  ds_read_b64_tr_b16 v[132:133], v16 offset:20608
  v_mfma_f32_16x16x32_bf16 v[196:199], v[140:143], v[80:83], v[196:199]
  ds_read_b64_tr_b16 v[134:135], v16 offset:23168
  v_mfma_f32_16x16x32_bf16 v[180:183], v[144:147], v[76:79], v[180:183]
  ds_read_b64_tr_b16 v[136:137], v16 offset:25600
  v_mfma_f32_16x16x32_bf16 v[200:203], v[144:147], v[80:83], v[200:203]
  ds_read_b64_tr_b16 v[138:139], v16 offset:28160
  s_waitcnt vmcnt(14)
  s_waitcnt lgkmcnt(8)
  v_mfma_f32_16x16x32_bf16 v[164:167], v[148:151], v[84:87], v[164:167]
  ds_read_b64_tr_b16 v[140:141], v16 offset:25632
  v_mfma_f32_16x16x32_bf16 v[184:187], v[148:151], v[88:91], v[184:187]
  ds_read_b64_tr_b16 v[142:143], v16 offset:28192
  v_mfma_f32_16x16x32_bf16 v[168:171], v[152:155], v[84:87], v[168:171]
  ds_read_b64_tr_b16 v[144:145], v16 offset:25664
  v_mfma_f32_16x16x32_bf16 v[188:191], v[152:155], v[88:91], v[188:191]
  ds_read_b64_tr_b16 v[146:147], v16 offset:28224
  s_waitcnt lgkmcnt(8)
  v_mfma_f32_16x16x32_bf16 v[172:175], v[156:159], v[84:87], v[172:175]
  ds_read_b64_tr_b16 v[148:149], v16 offset:25696
  v_mfma_f32_16x16x32_bf16 v[192:195], v[156:159], v[88:91], v[192:195]
  ds_read_b64_tr_b16 v[150:151], v16 offset:28256
  v_mfma_f32_16x16x32_bf16 v[176:179], v[160:163], v[84:87], v[176:179]
  ds_read_b64_tr_b16 v[152:153], v16 offset:25728
  v_mfma_f32_16x16x32_bf16 v[196:199], v[160:163], v[88:91], v[196:199]
  ds_read_b64_tr_b16 v[154:155], v16 offset:28288
  s_waitcnt lgkmcnt(8)
  v_mfma_f32_16x16x32_bf16 v[180:183], v[132:135], v[84:87], v[180:183]
  ds_read_b64_tr_b16 v[156:157], v16 offset:30720
  v_mfma_f32_16x16x32_bf16 v[200:203], v[132:135], v[88:91], v[200:203]
  ds_read_b64_tr_b16 v[158:159], v16 offset:33280
  s_waitcnt vmcnt(12)
  v_mfma_f32_16x16x32_bf16 v[164:167], v[136:139], v[92:95], v[164:167]
  ds_read_b64_tr_b16 v[160:161], v16 offset:30752
  v_mfma_f32_16x16x32_bf16 v[184:187], v[136:139], v[96:99], v[184:187]
  ds_read_b64_tr_b16 v[162:163], v16 offset:33312
  s_waitcnt lgkmcnt(8)
  v_mfma_f32_16x16x32_bf16 v[168:171], v[140:143], v[92:95], v[168:171]
  ds_read_b64_tr_b16 v[132:133], v16 offset:30784
  v_mfma_f32_16x16x32_bf16 v[188:191], v[140:143], v[96:99], v[188:191]
  ds_read_b64_tr_b16 v[134:135], v16 offset:33344
  v_mfma_f32_16x16x32_bf16 v[172:175], v[144:147], v[92:95], v[172:175]
  ds_read_b64_tr_b16 v[136:137], v16 offset:30816
  v_mfma_f32_16x16x32_bf16 v[192:195], v[144:147], v[96:99], v[192:195]
  ds_read_b64_tr_b16 v[138:139], v16 offset:33376
  s_waitcnt lgkmcnt(8)
  v_mfma_f32_16x16x32_bf16 v[176:179], v[148:151], v[92:95], v[176:179]
  ds_read_b64_tr_b16 v[140:141], v16 offset:30848
  v_mfma_f32_16x16x32_bf16 v[196:199], v[148:151], v[96:99], v[196:199]
  ds_read_b64_tr_b16 v[142:143], v16 offset:33408
  v_mfma_f32_16x16x32_bf16 v[180:183], v[152:155], v[92:95], v[180:183]
  ds_read_b64_tr_b16 v[144:145], v16 offset:35840
  v_mfma_f32_16x16x32_bf16 v[200:203], v[152:155], v[96:99], v[200:203]
  ds_read_b64_tr_b16 v[146:147], v16 offset:38400
  s_waitcnt vmcnt(10)
  s_waitcnt lgkmcnt(8)
  v_mfma_f32_16x16x32_bf16 v[164:167], v[156:159], v[100:103], v[164:167]
  ds_read_b64_tr_b16 v[148:149], v16 offset:35872
  v_mfma_f32_16x16x32_bf16 v[184:187], v[156:159], v[104:107], v[184:187]
  ds_read_b64_tr_b16 v[150:151], v16 offset:38432
  v_mfma_f32_16x16x32_bf16 v[168:171], v[160:163], v[100:103], v[168:171]
  ds_read_b64_tr_b16 v[152:153], v16 offset:35904
  v_mfma_f32_16x16x32_bf16 v[188:191], v[160:163], v[104:107], v[188:191]
  ds_read_b64_tr_b16 v[154:155], v16 offset:38464
  s_waitcnt lgkmcnt(8)
  v_mfma_f32_16x16x32_bf16 v[172:175], v[132:135], v[100:103], v[172:175]
  ds_read_b64_tr_b16 v[156:157], v16 offset:35936
  v_mfma_f32_16x16x32_bf16 v[192:195], v[132:135], v[104:107], v[192:195]
  ds_read_b64_tr_b16 v[158:159], v16 offset:38496
  v_mfma_f32_16x16x32_bf16 v[176:179], v[136:139], v[100:103], v[176:179]
  ds_read_b64_tr_b16 v[160:161], v16 offset:35968
  v_mfma_f32_16x16x32_bf16 v[196:199], v[136:139], v[104:107], v[196:199]
  ds_read_b64_tr_b16 v[162:163], v16 offset:38528
  s_waitcnt lgkmcnt(8)
  v_mfma_f32_16x16x32_bf16 v[180:183], v[140:143], v[100:103], v[180:183]
  ds_read_b64_tr_b16 v[132:133], v17 offset:0
  v_mfma_f32_16x16x32_bf16 v[200:203], v[140:143], v[104:107], v[200:203]
  ds_read_b64_tr_b16 v[134:135], v17 offset:2560
  s_waitcnt vmcnt(8)
  v_mfma_f32_16x16x32_bf16 v[164:167], v[144:147], v[108:111], v[164:167]
  ds_read_b64_tr_b16 v[136:137], v17 offset:32
  v_mfma_f32_16x16x32_bf16 v[184:187], v[144:147], v[112:115], v[184:187]
  ds_read_b64_tr_b16 v[138:139], v17 offset:2592
  s_waitcnt lgkmcnt(8)
  v_mfma_f32_16x16x32_bf16 v[168:171], v[148:151], v[108:111], v[168:171]
  ds_read_b64_tr_b16 v[140:141], v17 offset:64
  v_mfma_f32_16x16x32_bf16 v[188:191], v[148:151], v[112:115], v[188:191]
  ds_read_b64_tr_b16 v[142:143], v17 offset:2624
  v_mfma_f32_16x16x32_bf16 v[172:175], v[152:155], v[108:111], v[172:175]
  ds_read_b64_tr_b16 v[144:145], v17 offset:96
  v_mfma_f32_16x16x32_bf16 v[192:195], v[152:155], v[112:115], v[192:195]
  ds_read_b64_tr_b16 v[146:147], v17 offset:2656
  s_waitcnt lgkmcnt(8)
  v_mfma_f32_16x16x32_bf16 v[176:179], v[156:159], v[108:111], v[176:179]
  ds_read_b64_tr_b16 v[148:149], v17 offset:128
  v_mfma_f32_16x16x32_bf16 v[196:199], v[156:159], v[112:115], v[196:199]
  ds_read_b64_tr_b16 v[150:151], v17 offset:2688
  v_mfma_f32_16x16x32_bf16 v[180:183], v[160:163], v[108:111], v[180:183]
  ds_read_b64_tr_b16 v[152:153], v17 offset:5120
  v_mfma_f32_16x16x32_bf16 v[200:203], v[160:163], v[112:115], v[200:203]
  ds_read_b64_tr_b16 v[154:155], v17 offset:7680
  s_waitcnt vmcnt(4)
  s_waitcnt lgkmcnt(8)
  v_mfma_f32_16x16x32_bf16 v[164:167], v[132:135], v[116:119], v[164:167]
  ds_read_b64_tr_b16 v[156:157], v17 offset:5152
  v_mfma_f32_16x16x32_bf16 v[184:187], v[132:135], v[120:123], v[184:187]
  ds_read_b64_tr_b16 v[158:159], v17 offset:7712
  v_mfma_f32_16x16x32_bf16 v[168:171], v[136:139], v[116:119], v[168:171]
  ds_read_b64_tr_b16 v[160:161], v17 offset:5184
  v_mfma_f32_16x16x32_bf16 v[188:191], v[136:139], v[120:123], v[188:191]
  ds_read_b64_tr_b16 v[162:163], v17 offset:7744
  s_waitcnt lgkmcnt(8)
  v_mfma_f32_16x16x32_bf16 v[172:175], v[140:143], v[116:119], v[172:175]
  ds_read_b64_tr_b16 v[132:133], v17 offset:5216
  v_mfma_f32_16x16x32_bf16 v[192:195], v[140:143], v[120:123], v[192:195]
  ds_read_b64_tr_b16 v[134:135], v17 offset:7776
  v_mfma_f32_16x16x32_bf16 v[176:179], v[144:147], v[116:119], v[176:179]
  ds_read_b64_tr_b16 v[136:137], v17 offset:5248
  v_mfma_f32_16x16x32_bf16 v[196:199], v[144:147], v[120:123], v[196:199]
  ds_read_b64_tr_b16 v[138:139], v17 offset:7808
  s_waitcnt lgkmcnt(8)
  v_mfma_f32_16x16x32_bf16 v[180:183], v[148:151], v[116:119], v[180:183]
  v_mfma_f32_16x16x32_bf16 v[200:203], v[148:151], v[120:123], v[200:203]
  s_waitcnt vmcnt(0)
  v_mfma_f32_16x16x32_bf16 v[164:167], v[152:155], v[124:127], v[164:167]
  v_mfma_f32_16x16x32_bf16 v[184:187], v[152:155], v[128:131], v[184:187]
  s_waitcnt lgkmcnt(4)
  v_mfma_f32_16x16x32_bf16 v[168:171], v[156:159], v[124:127], v[168:171]
  v_mfma_f32_16x16x32_bf16 v[188:191], v[156:159], v[128:131], v[188:191]
  v_mfma_f32_16x16x32_bf16 v[172:175], v[160:163], v[124:127], v[172:175]
  v_mfma_f32_16x16x32_bf16 v[192:195], v[160:163], v[128:131], v[192:195]
  s_waitcnt lgkmcnt(0)
  v_mfma_f32_16x16x32_bf16 v[176:179], v[132:135], v[124:127], v[176:179]
  v_mfma_f32_16x16x32_bf16 v[196:199], v[132:135], v[128:131], v[196:199]
  v_mfma_f32_16x16x32_bf16 v[180:183], v[136:139], v[124:127], v[180:183]
  v_mfma_f32_16x16x32_bf16 v[200:203], v[136:139], v[128:131], v[200:203]
  v_cvt_pk_bf16_f32 v52, v164, v165
  v_cvt_pk_bf16_f32 v53, v166, v167
  ds_write_b64 v19, v[52:53] offset:0
  v_cvt_pk_bf16_f32 v54, v168, v169
  v_cvt_pk_bf16_f32 v55, v170, v171
  ds_write_b64 v19, v[54:55] offset:32
  v_cvt_pk_bf16_f32 v56, v172, v173
  v_cvt_pk_bf16_f32 v57, v174, v175
  ds_write_b64 v19, v[56:57] offset:64
  v_cvt_pk_bf16_f32 v58, v176, v177
  v_cvt_pk_bf16_f32 v59, v178, v179
  ds_write_b64 v19, v[58:59] offset:96
  v_cvt_pk_bf16_f32 v60, v180, v181
  v_cvt_pk_bf16_f32 v61, v182, v183
  ds_write_b64 v19, v[60:61] offset:128
  v_cvt_pk_bf16_f32 v72, v184, v185
  v_cvt_pk_bf16_f32 v73, v186, v187
  ds_write_b64 v19, v[72:73] offset:2560
  v_cvt_pk_bf16_f32 v74, v188, v189
  v_cvt_pk_bf16_f32 v75, v190, v191
  ds_write_b64 v19, v[74:75] offset:2592
  v_cvt_pk_bf16_f32 v76, v192, v193
  v_cvt_pk_bf16_f32 v77, v194, v195
  ds_write_b64 v19, v[76:77] offset:2624
  v_cvt_pk_bf16_f32 v78, v196, v197
  v_cvt_pk_bf16_f32 v79, v198, v199
  ds_write_b64 v19, v[78:79] offset:2656
  v_cvt_pk_bf16_f32 v80, v200, v201
  v_cvt_pk_bf16_f32 v81, v202, v203
  ds_write_b64 v19, v[80:81] offset:2688
  s_waitcnt lgkmcnt(0)
  ds_read_b128 v[92:95], v10 offset:0
  ds_read_b128 v[96:99], v10 offset:1024
  ds_read_b128 v[100:103], v10 offset:2048
  ds_read_b128 v[104:107], v10 offset:3072
  ds_read_b128 v[108:111], v10 offset:4096
  s_waitcnt lgkmcnt(4)
  buffer_store_dwordx4 v[92:95], v11, s[24:27], s48 offen
  s_waitcnt lgkmcnt(3)
  buffer_store_dwordx4 v[96:99], v12, s[24:27], s48 offen
  s_waitcnt lgkmcnt(2)
  buffer_store_dwordx4 v[100:103], v13, s[24:27], s48 offen
  s_waitcnt lgkmcnt(1)
  buffer_store_dwordx4 v[104:107], v14, s[24:27], s48 offen
  s_waitcnt lgkmcnt(0)
  buffer_store_dwordx4 v[108:111], v15, s[24:27], s48 offen
  s_branch f_done
f_hi:
  s_cmp_lg_u32 s45, 3
  s_cbranch_scc1 f_done
  s_cmp_lg_u32 s98, 0
  s_cbranch_scc1 f_p1n
  s_mov_b32 s64, 0x20000
f_po1_p:
  buffer_load_dword v9, v250, s[12:15], s65 offen sc1
  s_waitcnt vmcnt(0)
  v_cmp_ne_u32 vcc, s19, v9
  s_cbranch_vccz f_po1_d
  s_sleep 1
  s_sub_u32 s64, s64, 1
  s_cmp_lg_u32 s64, 0
  s_cbranch_scc1 f_po1_p
f_po1_d:
f_p1n:
  v_mov_b32 v9, 1
  s_mov_b64 exec, 1
  ds_add_u32 v49, v9 offset:56
  s_mov_b64 exec, -1
f_done:
f_end:
  s_endpgm
f_slow:
  s_waitcnt vmcnt(0)
  v_cmp_gt_u32 vcc, 32, v1
  v_mov_b32 v77, 0xff800000
  s_nop 0
  v_cndmask_b32 v68, 0, v68, vcc
  s_mov_b32 s54, 0
  s_mov_b32 s55, s63
f_s1:
  buffer_load_dwordx4 v[20:23], v2, s[12:15], s55 offen sc1
  buffer_load_dwordx2 v[44:45], v3, s[12:15], s55 offen offset:1024 sc1
  s_waitcnt vmcnt(0)
  v_mfma_f32_32x32x16_bf16 v[132:147], v[20:23], v[52:55], 0
  v_mfma_f32_32x32x8_bf16 v[132:147], v[44:45], v[68:69], v[132:147]
  s_nop 11
  v_max3_f32 v77, v132, v133, v77
  v_max3_f32 v77, v134, v135, v77
  v_max3_f32 v77, v136, v137, v77
  v_max3_f32 v77, v138, v139, v77
  v_max3_f32 v77, v140, v141, v77
  v_max3_f32 v77, v142, v143, v77
  v_max3_f32 v77, v144, v145, v77
  v_max3_f32 v77, v146, v147, v77
  s_add_u32 s55, s55, 2688
  s_add_u32 s54, s54, 1
  s_cmp_lt_u32 s54, 64
  s_cbranch_scc1 f_s1
  v_mov_b32 v78, v77
  s_nop 1
  v_permlane32_swap_b32 v77, v78
  v_max_f32 v77, v77, v78
  v_and_b32 v78, 0xffff0000, v77
  v_sub_f32 v77, v78, v77
  v_xor_b32 v78, 0x80000000, v78
  v_perm_b32 v79, v77, v78, s62
  v_cndmask_b32 v68, v79, v68, vcc
  v_mov_b32 v116, 0
  v_mov_b32 v117, 0
  v_mov_b32 v118, 0
  v_mov_b32 v119, 0
  v_mov_b32 v120, 0
  v_mov_b32 v121, 0
  v_mov_b32 v122, 0
  v_mov_b32 v123, 0
  v_mov_b32 v124, 0
  v_mov_b32 v125, 0
  v_mov_b32 v126, 0
  v_mov_b32 v127, 0
  v_mov_b32 v128, 0
  v_mov_b32 v129, 0
  v_mov_b32 v130, 0
  v_mov_b32 v131, 0
  s_mov_b32 s54, 0
  s_mov_b32 s55, s63
f_s2:
  buffer_load_dwordx4 v[20:23], v2, s[12:15], s55 offen sc1
  buffer_load_dwordx2 v[44:45], v3, s[12:15], s55 offen offset:1024 sc1
  buffer_load_dwordx4 v[28:31], v4, s[12:15], s55 offen offset:1280 sc1
  buffer_load_dwordx4 v[36:39], v4, s[12:15], s55 offen offset:1952 sc1
  s_waitcnt vmcnt(0)
  v_mfma_f32_32x32x16_bf16 v[132:147], v[20:23], v[52:55], 0
  v_mfma_f32_32x32x8_bf16 v[132:147], v[44:45], v[68:69], v[132:147]
  s_nop 11
  v_exp_f32 v132, v132
  v_exp_f32 v133, v133
  v_exp_f32 v134, v134
  v_exp_f32 v135, v135
  v_exp_f32 v136, v136
  v_exp_f32 v137, v137
  v_exp_f32 v138, v138
  v_exp_f32 v139, v139
  v_exp_f32 v140, v140
  v_exp_f32 v141, v141
  v_exp_f32 v142, v142
  v_exp_f32 v143, v143
  v_exp_f32 v144, v144
  v_exp_f32 v145, v145
  v_exp_f32 v146, v146
  v_exp_f32 v147, v147
  v_smfmac_f32_32x32x32_bf16 v[116:131], v[28:31], v[132:139], v5
  s_nop 0
  v_smfmac_f32_32x32x32_bf16 v[116:131], v[36:39], v[140:147], v5
  s_add_u32 s55, s55, 2688
  s_add_u32 s54, s54, 1
  s_cmp_lt_u32 s54, 64
  s_nop 7
  s_cbranch_scc1 f_s2
  s_nop 15
  v_mov_b32 v14, v124
  v_mov_b32 v15, v124
  s_nop 1
  v_permlane32_swap_b32 v14, v15
  s_nop 1
  s_branch f_fin
f_last:
.section .rodata,"a"
.p2align 6
.amdhsa_kernel concat_heads__mha_block__linear_attn_block__prompt_kernel
  .amdhsa_next_free_vgpr 256
  .amdhsa_next_free_sgpr 102
  .amdhsa_accum_offset 256
  .amdhsa_group_segment_fixed_size 0
  .amdhsa_kernarg_size 72
  .amdhsa_user_sgpr_count 2
  .amdhsa_user_sgpr_kernarg_segment_ptr 1
  .amdhsa_system_sgpr_workgroup_id_x 1
  .amdhsa_float_denorm_mode_32 3
.end_amdhsa_kernel
```
